```python
import torch

def _softmax(x, axis=-1):
    return torch.softmax(x, dim=axis)
def _gelu(x):
    return torch.nn.functional.gelu(x, approximate="tanh")
def _silu(x):
    return torch.nn.functional.silu(x)
def _sigmoid(x):
    return torch.sigmoid(x)
def _layernorm(x, axis=-1, eps=1e-5):
    m = x.mean(dim=axis, keepdim=True)
    v = x.var(dim=axis, keepdim=True, unbiased=False)
    return (x - m) / torch.sqrt(v + eps)
def _scatter_add(tgt, idx, src, axis=0):
    return tgt.clone().index_add_(axis, idx, src)
def _segment_sum(src, seg, n):
    out = torch.zeros((n,) + src.shape[1:], dtype=src.dtype)
    return out.index_add_(0, seg, src)
def _pad(x, pw):
    flat = tuple(v for pair in reversed(pw) for v in pair)
    return torch.nn.functional.pad(x, flat)

kernel_name = 'interleave_layers__gqa_block_cached__glu_gated_glu__decode'

def setup_inputs():

    _w = (lambda a: (lambda t: t.to(torch.bfloat16) if t.is_floating_point() else t)(torch.as_tensor(a)))
    def _A_setup():
        B, Sq, D = 1, 1, 512
        Hq, Hkv, Sk, Dh = 32, 32, 16384, 128
        assert Hq % Hkv == 0, (Hq, Hkv)
        return {
            "x": _w((lambda *s: torch.randn(*s, dtype=torch.bfloat16) * 0.05)(B, Sq, D)),
            "k_cache": _w((lambda *s: torch.randn(*s, dtype=torch.bfloat16) * 1.6)(B, Hkv, Sk, Dh)),
            "v_cache": _w((lambda *s: torch.randn(*s, dtype=torch.bfloat16) * 1.6)(B, Hkv, Sk, Dh)),
            "wq": _w((lambda *s: torch.randn(*s, dtype=torch.bfloat16) * 1.6)(D, Hq * Dh) * (D ** -0.5)),
            "wo": _w((lambda *s: torch.randn(*s, dtype=torch.bfloat16) * 1.6)(Hq * Dh, D) * ((Hq * Dh) ** -0.5)),
        }
    _A_in = _A_setup()

    def _B_setup():
        B, S, D, F = 1, 1, 512, 1376
        return {
            "x": _w((lambda *s: torch.randn(*s, dtype=torch.bfloat16) * 0.05)(B, S, D)),
            "w_gate": _w((lambda *s: torch.randn(*s, dtype=torch.bfloat16) * 0.05)(D, F)),
            "w_up": _w((lambda *s: torch.randn(*s, dtype=torch.bfloat16) * 0.05)(D, F)),
            "w_down": _w((lambda *s: torch.randn(*s, dtype=torch.bfloat16) * 0.05)(F, D)),
        }
    _B_in = _B_setup()

    return {
        "A_x": _A_in["x"],
        "A_k_cache": _A_in["k_cache"],
        "A_v_cache": _A_in["v_cache"],
        "A_wq": _A_in["wq"],
        "A_wo": _A_in["wo"],
        "B_x": _B_in["x"],
        "B_w_gate": _B_in["w_gate"],
        "B_w_up": _B_in["w_up"],
        "B_w_down": _B_in["w_down"],
    }

def reference(A_x, A_k_cache, A_v_cache, A_wq, A_wo, B_x, B_w_gate, B_w_up, B_w_down):
    def _A_ref(x, k_cache, v_cache, wq, wo):
        B, Sq, D = x.shape
        Hq, Dh = 32, 128
        Hkv = k_cache.shape[1]
        rep = Hq // Hkv
        q = (lambda x, *d: x.permute(*d))((x @ wq).reshape(B, Sq, Hq, Dh), 0, 2, 1, 3)
        k = (lambda x, n, axis: torch.repeat_interleave(x, n, dim=axis))(k_cache, rep, axis=1)
        v = (lambda x, n, axis: torch.repeat_interleave(x, n, dim=axis))(v_cache, rep, axis=1)
        scores = torch.einsum("bhqd,bhkd->bhqk", q, k) * (Dh ** -0.5)
        p = _softmax(scores, axis=-1)
        o = torch.einsum("bhqk,bhkd->bhqd", p, v)
        return (lambda x, *d: x.permute(*d))(o, 0, 2, 1, 3).reshape(B, Sq, Hq * Dh) @ wo

    def _B_ref(x, w_gate, w_up, w_down):
        g = torch.einsum("bsd,df->bsf", x, w_gate)
        u = torch.einsum("bsd,df->bsf", x, w_up)
        h = _sigmoid(g) * u
        return torch.einsum("bsf,fd->bsd", h, w_down)

    x = A_x
    x = x + _A_ref(_layernorm(x, axis=-1), A_k_cache, A_v_cache, A_wq, A_wo)
    x = x + _B_ref(_layernorm(x, axis=-1), B_w_gate, B_w_up, B_w_down)
    x = x + _A_ref(_layernorm(x, axis=-1), A_k_cache, A_v_cache, A_wq, A_wo)
    x = x + _B_ref(_layernorm(x, axis=-1), B_w_gate, B_w_up, B_w_down)
    return x
```

```asm
; @launch grid=(256,1,1) block=(256,1,1) lds=163840
.amdgcn_target "amdgcn-amd-amdhsa--gfx950"
.text
.globl interleave_layers__gqa_block_cached__glu_gated_glu__decode_kernel
.p2align 8
.type interleave_layers__gqa_block_cached__glu_gated_glu__decode_kernel,@function
interleave_layers__gqa_block_cached__glu_gated_glu__decode_kernel:
  s_cmp_ge_u32 s2, 256
  s_cbranch_scc1 L_end
  s_load_dwordx16 s[16:31], s[0:1], 0
  s_load_dwordx8 s[32:39], s[0:1], 64
  v_lshrrev_b32 v4, 6, v0
  v_and_b32 v0, 63, v0
  v_readfirstlane_b32 s3, v4
  v_and_b32 v4, 15, v0
  v_lshrrev_b32 v5, 4, v0
  v_xor_b32 v2, v4, v5
  v_lshlrev_b32 v2, 4, v2
  v_lshl_add_u32 v2, v5, 8, v2
  s_and_b32 s4, s2, 31
  s_lshr_b32 s5, s2, 5
  s_lshl_b32 s6, s4, 22
  s_lshl_b32 s7, s5, 19
  s_add_u32 s6, s6, s7
  s_lshl_b32 s7, s3, 12
  s_add_u32 s6, s6, s7
  s_mul_i32 s49, s3, 38912
  s_add_u32 s49, s49, 7168
  s_mov_b32 s42, 0x8000000
  s_mov_b32 s43, 0x20000
  s_mov_b32 s46, 0x8000000
  s_mov_b32 s47, 0x20000
  s_mov_b32 s10, 0
  s_waitcnt lgkmcnt(0)
  s_mov_b32 s40, s18
  s_and_b32 s41, s19, 0xffff
  s_add_u32 s7, s6, 0
  s_add_u32 m0, s49, 17408
  s_nop 0
  buffer_load_dwordx4 v2, s[40:43], s7 offen offset:0 nt lds
  v_xor_b32 v51, 64, v2
  buffer_load_dwordx4 v51, s[40:43], s7 offen offset:1024 nt lds
  v_xor_b32 v50, 128, v2
  buffer_load_dwordx4 v50, s[40:43], s7 offen offset:2048 nt lds
  v_xor_b32 v51, 192, v2
  buffer_load_dwordx4 v51, s[40:43], s7 offen offset:3072 nt lds
  s_add_u32 s7, s6, 16384
  s_add_u32 m0, s49, 21504
  s_nop 0
  buffer_load_dwordx4 v2, s[40:43], s7 offen offset:0 nt lds
  v_xor_b32 v51, 64, v2
  buffer_load_dwordx4 v51, s[40:43], s7 offen offset:1024 nt lds
  v_xor_b32 v50, 128, v2
  buffer_load_dwordx4 v50, s[40:43], s7 offen offset:2048 nt lds
  v_xor_b32 v51, 192, v2
  buffer_load_dwordx4 v51, s[40:43], s7 offen offset:3072 nt lds
  s_add_u32 s7, s6, 32768
  s_add_u32 m0, s49, 25600
  s_nop 0
  buffer_load_dwordx4 v2, s[40:43], s7 offen offset:0 nt lds
  v_xor_b32 v51, 64, v2
  buffer_load_dwordx4 v51, s[40:43], s7 offen offset:1024 nt lds
  v_xor_b32 v50, 128, v2
  buffer_load_dwordx4 v50, s[40:43], s7 offen offset:2048 nt lds
  v_xor_b32 v51, 192, v2
  buffer_load_dwordx4 v51, s[40:43], s7 offen offset:3072 nt lds
  s_add_u32 s7, s6, 49152
  s_add_u32 m0, s49, 29696
  s_nop 0
  buffer_load_dwordx4 v2, s[40:43], s7 offen offset:0 nt lds
  v_xor_b32 v51, 64, v2
  buffer_load_dwordx4 v51, s[40:43], s7 offen offset:1024 nt lds
  v_xor_b32 v50, 128, v2
  buffer_load_dwordx4 v50, s[40:43], s7 offen offset:2048 nt lds
  v_xor_b32 v51, 192, v2
  buffer_load_dwordx4 v51, s[40:43], s7 offen offset:3072 nt lds
  s_add_u32 s7, s6, 65536
  s_add_u32 m0, s49, 33792
  s_nop 0
  buffer_load_dwordx4 v2, s[40:43], s7 offen offset:0 nt lds
  v_xor_b32 v51, 64, v2
  buffer_load_dwordx4 v51, s[40:43], s7 offen offset:1024 nt lds
  v_xor_b32 v50, 128, v2
  buffer_load_dwordx4 v50, s[40:43], s7 offen offset:2048 nt lds
  v_xor_b32 v51, 192, v2
  buffer_load_dwordx4 v51, s[40:43], s7 offen offset:3072 nt lds
  s_add_u32 s7, s6, 81920
  s_add_u32 m0, s49, 1024
  s_nop 0
  buffer_load_dwordx4 v2, s[40:43], s7 offen offset:0 nt lds
  v_xor_b32 v51, 64, v2
  buffer_load_dwordx4 v51, s[40:43], s7 offen offset:1024 nt lds
  v_xor_b32 v50, 128, v2
  buffer_load_dwordx4 v50, s[40:43], s7 offen offset:2048 nt lds
  v_xor_b32 v51, 192, v2
  buffer_load_dwordx4 v51, s[40:43], s7 offen offset:3072 nt lds
  s_mov_b32 s44, s20
  s_and_b32 s45, s21, 0xffff
  v_lshlrev_b32 v3, 4, v0
  global_load_dwordx4 v[52:55], v3, s[16:17]
  v_lshlrev_b32 v1, 10, v5
  v_lshl_add_u32 v1, v4, 4, v1
  s_mov_b32 s8, 0x3fb8aa3b
  s_mov_b32 s9, 0x3db504f3
  s_mov_b32 s11, 400000
  s_and_b32 s12, s2, 7
  s_lshr_b32 s13, s2, 3
  s_lshr_b32 s14, s13, 3
  s_lshl_b32 s14, s14, 3
  s_add_u32 s14, s14, s12
  s_lshl_b32 s14, s14, 3
  s_and_b32 s13, s13, 7
  s_add_u32 s48, s14, s13
  s_sub_u32 s50, s2, 192
  s_lshr_b32 s50, s50, 3
  s_and_b32 s50, s50, 7
  s_and_b32 s12, s2, 7
  s_lshl_b32 s12, s12, 3
  s_add_u32 s50, s50, s12
  s_add_u32 s26, s38, 2097152
  s_addc_u32 s27, s39, 0
  s_lshl_b32 s74, s2, 2
  s_add_u32 s74, s74, s3
  s_lshl_b32 s74, s74, 7
  s_mov_b32 s52, 0x00010001
  s_mov_b32 s53, 0x00010001
  v_lshlrev_b32 v5, 13, v5
  v_lshl_add_u32 v48, v4, 4, v5
  s_lshl_b32 s12, s4, 8
  s_lshl_b32 s13, s3, 20
  s_add_u32 s12, s12, s13
  v_add_u32 v48, s12, v48
  v_mov_b32 v248, 0
  v_mov_b32 v249, 0
  v_mov_b32 v250, 0
  v_mov_b32 v251, 0
  v_mov_b32 v252, 0
  v_mov_b32 v253, 0
  v_mov_b32 v254, 0
  v_mov_b32 v255, 0
  s_cmp_ge_u32 s2, 192
  s_cbranch_scc1 L_pd_1
  s_min_u32 s12, s48, 171
  s_lshl_b32 s12, s12, 4
  s_mul_i32 s13, s3, 352256
  s_add_u32 s12, s12, s13
  v_mul_u32_u24 v7, 2752, v0
  v_add_u32 v7, s12, v7
  v_add_u32 v6, 176128, v7
  global_load_dwordx4 v[232:235], v7, s[28:29]
  global_load_dwordx4 v[236:239], v6, s[28:29]
  global_load_dwordx4 v[240:243], v7, s[30:31]
  global_load_dwordx4 v[244:247], v6, s[30:31]
  global_load_dword v248, v3, s[16:17]
  global_load_dword v252, v3, s[16:17]
  s_branch L_pe_2
L_pd_1:
  s_nop 4
  s_mul_i32 s12, s3, 352256
  s_lshl_b32 s13, s50, 4
  s_add_u32 s12, s12, s13
  v_lshlrev_b32 v7, 11, v0
  v_add_u32 v7, s12, v7
  global_load_dwordx4 v[232:235], v7, s[32:33]
  global_load_dwordx4 v[236:239], v7, s[32:33] offset:1024
  v_add_u32 v7, 131072, v7
  global_load_dwordx4 v[240:243], v7, s[32:33]
  global_load_dwordx4 v[244:247], v7, s[32:33] offset:1024
  v_add_u32 v7, 131072, v7
  s_mov_b32 exec_hi, 0xfff
  global_load_dwordx4 v[248:251], v7, s[32:33]
  global_load_dwordx4 v[252:255], v7, s[32:33] offset:1024
  s_mov_b64 exec, -1
L_pe_2:
  s_nop 4
  s_mov_b64 exec, 1
  s_getreg_b32 s76, hwreg(HW_REG_XCC_ID)
  s_and_b32 s76, s76, 15
  s_add_u32 s76, s76, 1
  s_mov_b32 s75, 0
  v_mov_b32 v7, s74
  v_mov_b32 v50, 0
  v_mov_b32 v51, s76
  global_store_dwordx2 v7, v[50:51], s[26:27] sc1
  s_mov_b64 exec, -1
  s_waitcnt vmcnt(7)
  global_load_dwordx4 v[168:171], v48, s[22:23]
  v_add_u32 v48, 0x8000, v48
  global_load_dwordx4 v[172:175], v48, s[22:23]
  v_add_u32 v48, 0x8000, v48
  global_load_dwordx4 v[176:179], v48, s[22:23]
  v_add_u32 v48, 0x8000, v48
  global_load_dwordx4 v[180:183], v48, s[22:23]
  v_add_u32 v48, 0x8000, v48
  v_lshlrev_b32 v24, 16, v52
  v_and_b32 v25, 0xffff0000, v52
  v_lshlrev_b32 v26, 16, v53
  v_and_b32 v27, 0xffff0000, v53
  v_lshlrev_b32 v28, 16, v54
  v_and_b32 v29, 0xffff0000, v54
  v_lshlrev_b32 v30, 16, v55
  v_and_b32 v31, 0xffff0000, v55
  v_add_f32 v4, v24, v25
  v_add_f32 v5, v26, v27
  v_add_f32 v6, v28, v29
  v_add_f32 v32, v30, v31
  v_add_f32 v4, v4, v5
  v_add_f32 v6, v6, v32
  v_add_f32 v4, v4, v6
  s_nop 1
  v_add_f32_dpp v4, v4, v4 quad_perm:[1,0,3,2] row_mask:0xf bank_mask:0xf
  s_nop 1
  v_add_f32_dpp v4, v4, v4 quad_perm:[2,3,0,1] row_mask:0xf bank_mask:0xf
  s_nop 1
  v_add_f32_dpp v4, v4, v4 row_half_mirror row_mask:0xf bank_mask:0xf
  s_nop 1
  v_add_f32_dpp v4, v4, v4 row_mirror row_mask:0xf bank_mask:0xf
  v_mov_b32 v5, v4
  s_nop 1
  v_permlane16_swap_b32 v5, v4
  v_add_f32 v4, v4, v5
  v_mov_b32 v5, v4
  s_nop 1
  v_permlane32_swap_b32 v5, v4
  v_add_f32 v4, v4, v5
  v_mul_f32 v4, 0x3b000000, v4
  v_sub_f32 v32, v24, v4
  v_sub_f32 v33, v25, v4
  v_sub_f32 v34, v26, v4
  v_sub_f32 v35, v27, v4
  v_sub_f32 v36, v28, v4
  v_sub_f32 v37, v29, v4
  v_sub_f32 v38, v30, v4
  v_sub_f32 v39, v31, v4
  v_mul_f32 v6, v32, v32
  v_mul_f32 v5, v33, v33
  v_fmac_f32 v6, v34, v34
  v_fmac_f32 v5, v35, v35
  v_fmac_f32 v6, v36, v36
  v_fmac_f32 v5, v37, v37
  v_fmac_f32 v6, v38, v38
  v_fmac_f32 v5, v39, v39
  v_add_f32 v6, v6, v5
  v_cvt_pk_bf16_f32 v4, v4, v4
  v_and_b32 v4, 0xffff0000, v4
  v_add_f32_dpp v6, v6, v6 quad_perm:[1,0,3,2] row_mask:0xf bank_mask:0xf
  s_nop 1
  v_add_f32_dpp v6, v6, v6 quad_perm:[2,3,0,1] row_mask:0xf bank_mask:0xf
  s_nop 1
  v_add_f32_dpp v6, v6, v6 row_half_mirror row_mask:0xf bank_mask:0xf
  s_nop 1
  v_add_f32_dpp v6, v6, v6 row_mirror row_mask:0xf bank_mask:0xf
  v_mov_b32 v5, v6
  s_nop 1
  v_permlane16_swap_b32 v5, v6
  v_add_f32 v6, v6, v5
  v_mov_b32 v5, v6
  s_nop 1
  v_permlane32_swap_b32 v5, v6
  v_add_f32 v6, v6, v5
  v_sub_f32 v32, v24, v4
  v_sub_f32 v33, v25, v4
  v_sub_f32 v34, v26, v4
  v_sub_f32 v35, v27, v4
  v_sub_f32 v36, v28, v4
  v_sub_f32 v37, v29, v4
  v_sub_f32 v38, v30, v4
  v_sub_f32 v39, v31, v4
  v_mul_f32 v6, 0x3b000000, v6
  v_cvt_pk_bf16_f32 v6, v6, v6
  v_and_b32 v6, 0xffff0000, v6
  v_add_f32 v6, 0x3727c5ac, v6
  v_cvt_pk_bf16_f32 v6, v6, v6
  v_and_b32 v6, 0xffff0000, v6
  v_sqrt_f32 v6, v6
  v_cvt_pk_bf16_f32 v24, v32, v33
  v_cvt_pk_bf16_f32 v26, v34, v35
  v_cvt_pk_bf16_f32 v28, v36, v37
  v_cvt_pk_bf16_f32 v30, v38, v39
  v_cvt_pk_bf16_f32 v6, v6, v6
  v_and_b32 v6, 0xffff0000, v6
  v_rcp_f32 v5, v6
  v_and_b32 v25, 0xffff0000, v24
  v_lshlrev_b32 v24, 16, v24
  v_and_b32 v27, 0xffff0000, v26
  v_lshlrev_b32 v26, 16, v26
  v_and_b32 v29, 0xffff0000, v28
  v_lshlrev_b32 v28, 16, v28
  v_and_b32 v31, 0xffff0000, v30
  v_lshlrev_b32 v30, 16, v30
  v_mul_f32 v32, v24, v5
  v_mul_f32 v33, v25, v5
  v_mul_f32 v34, v26, v5
  v_mul_f32 v35, v27, v5
  v_mul_f32 v36, v28, v5
  v_mul_f32 v37, v29, v5
  v_mul_f32 v38, v30, v5
  v_mul_f32 v39, v31, v5
  v_fma_f32 v24, -v32, v6, v24
  v_fma_f32 v25, -v33, v6, v25
  v_fma_f32 v26, -v34, v6, v26
  v_fma_f32 v27, -v35, v6, v27
  v_fma_f32 v28, -v36, v6, v28
  v_fma_f32 v29, -v37, v6, v29
  v_fma_f32 v30, -v38, v6, v30
  v_fma_f32 v31, -v39, v6, v31
  v_fmac_f32 v32, v24, v5
  v_fmac_f32 v33, v25, v5
  v_fmac_f32 v34, v26, v5
  v_fmac_f32 v35, v27, v5
  v_fmac_f32 v36, v28, v5
  v_fmac_f32 v37, v29, v5
  v_fmac_f32 v38, v30, v5
  v_fmac_f32 v39, v31, v5
  v_cvt_pk_bf16_f32 v24, v32, v33
  v_cvt_pk_bf16_f32 v26, v34, v35
  v_cvt_pk_bf16_f32 v28, v36, v37
  v_cvt_pk_bf16_f32 v30, v38, v39
  v_lshlrev_b32 v32, 16, v24
  v_and_b32 v33, 0xffff0000, v24
  v_lshlrev_b32 v34, 16, v26
  v_and_b32 v35, 0xffff0000, v26
  v_lshlrev_b32 v36, 16, v28
  v_and_b32 v37, 0xffff0000, v28
  v_lshlrev_b32 v38, 16, v30
  v_and_b32 v39, 0xffff0000, v30
  v_lshrrev_b32 v4, 4, v0
  v_lshlrev_b32 v4, 9, v4
  v_and_b32 v5, 15, v0
  v_lshl_add_u32 v4, v5, 3, v4
  ds_write2_b32 v4, v32, v36 offset0:0 offset1:1
  ds_write2_b32 v4, v33, v37 offset0:32 offset1:33
  ds_write2_b32 v4, v34, v38 offset0:64 offset1:65
  ds_write2_b32 v4, v35, v39 offset0:96 offset1:97
  v_lshrrev_b32 v5, 4, v0
  v_lshlrev_b32 v5, 7, v5
  s_lshl_b32 s12, s3, 9
  v_add_u32 v5, s12, v5
  s_waitcnt lgkmcnt(0)
  ds_read_b128 v[8:11], v5 offset:0
  ds_read_b128 v[12:15], v5 offset:16
  ds_read_b128 v[16:19], v5 offset:32
  ds_read_b128 v[20:23], v5 offset:48
  ds_read_b128 v[24:27], v5 offset:64
  ds_read_b128 v[28:31], v5 offset:80
  ds_read_b128 v[32:35], v5 offset:96
  ds_read_b128 v[36:39], v5 offset:112
  s_mul_i32 s12, s2, 4864
  s_mul_i32 s13, s3, 1216
  s_add_u32 s12, s12, s13
  s_add_u32 s12, s38, s12
  s_addc_u32 s13, s39, 0
  v_mov_b32 v40, -1
  v_mov_b32 v41, -1
  v_mov_b32 v42, -1
  v_mov_b32 v43, -1
  global_store_dwordx4 v3, v[40:43], s[12:13] sc1
  s_mov_b64 exec, 0xfff
  global_store_dwordx4 v3, v[40:43], s[12:13] offset:1024 sc1
  s_mov_b64 exec, -1
  v_and_b32 v4, 15, v0
  v_lshrrev_b32 v5, 4, v0
  v_xor_b32 v5, v5, v4
  v_lshlrev_b32 v5, 4, v5
  v_lshl_add_u32 v4, v4, 8, v5
  v_add_u32 v52, s49, v4
  v_xor_b32 v53, 64, v52
  v_xor_b32 v54, 128, v52
  v_xor_b32 v55, 192, v52
  v_mov_b32 v40, 0
  v_mov_b32 v41, 0
  v_mov_b32 v42, 0
  v_mov_b32 v43, 0
  v_mov_b32 v44, 0
  v_mov_b32 v45, 0
  v_mov_b32 v46, 0
  v_mov_b32 v47, 0
  s_waitcnt lgkmcnt(0)
  ds_read_b128 a[0:3], v52 offset:17408
  ds_read_b128 a[4:7], v53 offset:17408
  ds_read_b128 a[8:11], v54 offset:17408
  ds_read_b128 a[12:15], v55 offset:17408
  s_waitcnt lgkmcnt(0)
  ds_read_b128 a[16:19], v52 offset:21504
  ds_read_b128 a[20:23], v53 offset:21504
  ds_read_b128 a[24:27], v54 offset:21504
  ds_read_b128 a[28:31], v55 offset:21504
  s_waitcnt lgkmcnt(0)
  ds_read_b128 a[32:35], v52 offset:25600
  ds_read_b128 a[36:39], v53 offset:25600
  ds_read_b128 a[40:43], v54 offset:25600
  ds_read_b128 a[44:47], v55 offset:25600
  s_waitcnt lgkmcnt(0)
  ds_read_b128 a[48:51], v52 offset:29696
  ds_read_b128 a[52:55], v53 offset:29696
  ds_read_b128 a[56:59], v54 offset:29696
  ds_read_b128 a[60:63], v55 offset:29696
  s_waitcnt lgkmcnt(0)
  ds_read_b128 a[64:67], v52 offset:33792
  ds_read_b128 a[68:71], v53 offset:33792
  ds_read_b128 a[72:75], v54 offset:33792
  ds_read_b128 a[76:79], v55 offset:33792
  s_waitcnt lgkmcnt(0)
  ds_read_b128 a[80:83], v52 offset:1024
  ds_read_b128 a[84:87], v53 offset:1024
  ds_read_b128 a[88:91], v54 offset:1024
  ds_read_b128 a[92:95], v55 offset:1024
  s_waitcnt lgkmcnt(0)
  s_waitcnt vmcnt(5)
  s_add_u32 s7, s6, 98304
  s_add_u32 m0, s49, 5120
  s_nop 0
  buffer_load_dwordx4 v2, s[40:43], s7 offen offset:0 nt lds
  v_xor_b32 v51, 64, v2
  buffer_load_dwordx4 v51, s[40:43], s7 offen offset:1024 nt lds
  v_xor_b32 v50, 128, v2
  buffer_load_dwordx4 v50, s[40:43], s7 offen offset:2048 nt lds
  v_xor_b32 v51, 192, v2
  buffer_load_dwordx4 v51, s[40:43], s7 offen offset:3072 nt lds
  global_load_dwordx4 v[184:187], v48, s[22:23]
  v_add_u32 v48, 0x8000, v48
  global_load_dwordx4 v[188:191], v48, s[22:23]
  v_add_u32 v48, 0x8000, v48
  global_load_dwordx4 v[192:195], v48, s[22:23]
  v_add_u32 v48, 0x8000, v48
  v_lshrrev_b32 v49, 16, v8
  v_dot2c_f32_bf16 v40, v168, v49
  v_dot2c_f32_bf16 v41, v168, v8
  v_dot2c_f32_bf16 v42, v169, v49
  v_dot2c_f32_bf16 v43, v169, v8
  v_dot2c_f32_bf16 v44, v170, v49
  v_dot2c_f32_bf16 v45, v170, v8
  v_dot2c_f32_bf16 v46, v171, v49
  v_dot2c_f32_bf16 v47, v171, v8
  s_waitcnt vmcnt(11)
  global_load_dwordx4 v[196:199], v48, s[22:23]
  v_add_u32 v48, 0x8000, v48
  v_lshrrev_b32 v49, 16, v9
  v_dot2c_f32_bf16 v40, v172, v49
  v_dot2c_f32_bf16 v41, v172, v9
  v_dot2c_f32_bf16 v42, v173, v49
  v_dot2c_f32_bf16 v43, v173, v9
  v_dot2c_f32_bf16 v44, v174, v49
  v_dot2c_f32_bf16 v45, v174, v9
  v_dot2c_f32_bf16 v46, v175, v49
  v_dot2c_f32_bf16 v47, v175, v9
  s_waitcnt vmcnt(11)
  v_lshrrev_b32 v49, 16, v10
  v_dot2c_f32_bf16 v40, v176, v49
  v_dot2c_f32_bf16 v41, v176, v10
  v_dot2c_f32_bf16 v42, v177, v49
  v_dot2c_f32_bf16 v43, v177, v10
  v_dot2c_f32_bf16 v44, v178, v49
  v_dot2c_f32_bf16 v45, v178, v10
  v_dot2c_f32_bf16 v46, v179, v49
  v_dot2c_f32_bf16 v47, v179, v10
  s_waitcnt vmcnt(10)
  v_lshrrev_b32 v49, 16, v11
  v_dot2c_f32_bf16 v40, v180, v49
  v_dot2c_f32_bf16 v41, v180, v11
  v_dot2c_f32_bf16 v42, v181, v49
  v_dot2c_f32_bf16 v43, v181, v11
  v_dot2c_f32_bf16 v44, v182, v49
  v_dot2c_f32_bf16 v45, v182, v11
  v_dot2c_f32_bf16 v46, v183, v49
  v_dot2c_f32_bf16 v47, v183, v11
  s_waitcnt vmcnt(4)
  ds_read_b128 a[96:99], v52 offset:5120
  ds_read_b128 a[100:103], v53 offset:5120
  ds_read_b128 a[104:107], v54 offset:5120
  ds_read_b128 a[108:111], v55 offset:5120
  s_waitcnt lgkmcnt(0)
  s_add_u32 s7, s6, 114688
  s_add_u32 m0, s49, 9216
  s_nop 0
  buffer_load_dwordx4 v2, s[40:43], s7 offen offset:0 nt lds
  v_xor_b32 v51, 64, v2
  buffer_load_dwordx4 v51, s[40:43], s7 offen offset:1024 nt lds
  v_xor_b32 v50, 128, v2
  buffer_load_dwordx4 v50, s[40:43], s7 offen offset:2048 nt lds
  v_xor_b32 v51, 192, v2
  buffer_load_dwordx4 v51, s[40:43], s7 offen offset:3072 nt lds
  global_load_dwordx4 v[200:203], v48, s[22:23]
  v_add_u32 v48, 0x8000, v48
  global_load_dwordx4 v[204:207], v48, s[22:23]
  v_add_u32 v48, 0x8000, v48
  global_load_dwordx4 v[208:211], v48, s[22:23]
  v_add_u32 v48, 0x8000, v48
  global_load_dwordx4 v[212:215], v48, s[22:23]
  v_add_u32 v48, 0x8000, v48
  s_waitcnt vmcnt(11)
  v_lshrrev_b32 v49, 16, v12
  v_dot2c_f32_bf16 v40, v184, v49
  v_dot2c_f32_bf16 v41, v184, v12
  v_dot2c_f32_bf16 v42, v185, v49
  v_dot2c_f32_bf16 v43, v185, v12
  v_dot2c_f32_bf16 v44, v186, v49
  v_dot2c_f32_bf16 v45, v186, v12
  v_dot2c_f32_bf16 v46, v187, v49
  v_dot2c_f32_bf16 v47, v187, v12
  s_waitcnt vmcnt(10)
  v_lshrrev_b32 v49, 16, v13
  v_dot2c_f32_bf16 v40, v188, v49
  v_dot2c_f32_bf16 v41, v188, v13
  v_dot2c_f32_bf16 v42, v189, v49
  v_dot2c_f32_bf16 v43, v189, v13
  v_dot2c_f32_bf16 v44, v190, v49
  v_dot2c_f32_bf16 v45, v190, v13
  v_dot2c_f32_bf16 v46, v191, v49
  v_dot2c_f32_bf16 v47, v191, v13
  s_waitcnt vmcnt(9)
  v_lshrrev_b32 v49, 16, v14
  v_dot2c_f32_bf16 v40, v192, v49
  v_dot2c_f32_bf16 v41, v192, v14
  v_dot2c_f32_bf16 v42, v193, v49
  v_dot2c_f32_bf16 v43, v193, v14
  v_dot2c_f32_bf16 v44, v194, v49
  v_dot2c_f32_bf16 v45, v194, v14
  v_dot2c_f32_bf16 v46, v195, v49
  v_dot2c_f32_bf16 v47, v195, v14
  s_waitcnt vmcnt(8)
  s_add_u32 s7, s6, 131072
  s_add_u32 m0, s49, 13312
  s_nop 0
  buffer_load_dwordx4 v2, s[40:43], s7 offen offset:0 nt lds
  v_xor_b32 v51, 64, v2
  buffer_load_dwordx4 v51, s[40:43], s7 offen offset:1024 nt lds
  v_xor_b32 v50, 128, v2
  buffer_load_dwordx4 v50, s[40:43], s7 offen offset:2048 nt lds
  v_xor_b32 v51, 192, v2
  buffer_load_dwordx4 v51, s[40:43], s7 offen offset:3072 nt lds
  v_lshrrev_b32 v49, 16, v15
  v_dot2c_f32_bf16 v40, v196, v49
  v_dot2c_f32_bf16 v41, v196, v15
  v_dot2c_f32_bf16 v42, v197, v49
  v_dot2c_f32_bf16 v43, v197, v15
  v_dot2c_f32_bf16 v44, v198, v49
  v_dot2c_f32_bf16 v45, v198, v15
  v_dot2c_f32_bf16 v46, v199, v49
  v_dot2c_f32_bf16 v47, v199, v15
  s_waitcnt vmcnt(8)
  ds_read_b128 a[112:115], v52 offset:9216
  ds_read_b128 a[116:119], v53 offset:9216
  ds_read_b128 a[120:123], v54 offset:9216
  ds_read_b128 a[124:127], v55 offset:9216
  s_waitcnt lgkmcnt(0)
  global_load_dwordx4 v[216:219], v48, s[22:23]
  v_add_u32 v48, 0x8000, v48
  global_load_dwordx4 v[220:223], v48, s[22:23]
  v_add_u32 v48, 0x8000, v48
  global_load_dwordx4 v[224:227], v48, s[22:23]
  v_add_u32 v48, 0x8000, v48
  global_load_dwordx4 v[228:231], v48, s[22:23]
  v_add_u32 v48, 0x8000, v48
  s_waitcnt vmcnt(11)
  v_lshrrev_b32 v49, 16, v16
  v_dot2c_f32_bf16 v40, v200, v49
  v_dot2c_f32_bf16 v41, v200, v16
  v_dot2c_f32_bf16 v42, v201, v49
  v_dot2c_f32_bf16 v43, v201, v16
  v_dot2c_f32_bf16 v44, v202, v49
  v_dot2c_f32_bf16 v45, v202, v16
  v_dot2c_f32_bf16 v46, v203, v49
  v_dot2c_f32_bf16 v47, v203, v16
  s_waitcnt vmcnt(10)
  v_lshrrev_b32 v49, 16, v17
  v_dot2c_f32_bf16 v40, v204, v49
  v_dot2c_f32_bf16 v41, v204, v17
  v_dot2c_f32_bf16 v42, v205, v49
  v_dot2c_f32_bf16 v43, v205, v17
  v_dot2c_f32_bf16 v44, v206, v49
  v_dot2c_f32_bf16 v45, v206, v17
  v_dot2c_f32_bf16 v46, v207, v49
  v_dot2c_f32_bf16 v47, v207, v17
  s_waitcnt vmcnt(9)
  v_lshrrev_b32 v49, 16, v18
  v_dot2c_f32_bf16 v40, v208, v49
  v_dot2c_f32_bf16 v41, v208, v18
  v_dot2c_f32_bf16 v42, v209, v49
  v_dot2c_f32_bf16 v43, v209, v18
  v_dot2c_f32_bf16 v44, v210, v49
  v_dot2c_f32_bf16 v45, v210, v18
  v_dot2c_f32_bf16 v46, v211, v49
  v_dot2c_f32_bf16 v47, v211, v18
  s_waitcnt vmcnt(8)
  s_add_u32 s7, s6, 147456
  s_add_u32 m0, s49, 17408
  s_nop 0
  buffer_load_dwordx4 v2, s[40:43], s7 offen offset:0 nt lds
  v_xor_b32 v51, 64, v2
  buffer_load_dwordx4 v51, s[40:43], s7 offen offset:1024 nt lds
  v_xor_b32 v50, 128, v2
  buffer_load_dwordx4 v50, s[40:43], s7 offen offset:2048 nt lds
  v_xor_b32 v51, 192, v2
  buffer_load_dwordx4 v51, s[40:43], s7 offen offset:3072 nt lds
  v_lshrrev_b32 v49, 16, v19
  v_dot2c_f32_bf16 v40, v212, v49
  v_dot2c_f32_bf16 v41, v212, v19
  v_dot2c_f32_bf16 v42, v213, v49
  v_dot2c_f32_bf16 v43, v213, v19
  v_dot2c_f32_bf16 v44, v214, v49
  v_dot2c_f32_bf16 v45, v214, v19
  v_dot2c_f32_bf16 v46, v215, v49
  v_dot2c_f32_bf16 v47, v215, v19
  s_waitcnt vmcnt(8)
  ds_read_b128 a[128:131], v52 offset:13312
  ds_read_b128 a[132:135], v53 offset:13312
  ds_read_b128 a[136:139], v54 offset:13312
  ds_read_b128 a[140:143], v55 offset:13312
  s_waitcnt lgkmcnt(0)
  global_load_dwordx4 v[104:107], v48, s[22:23]
  v_add_u32 v48, 0x8000, v48
  global_load_dwordx4 v[108:111], v48, s[22:23]
  v_add_u32 v48, 0x8000, v48
  global_load_dwordx4 v[112:115], v48, s[22:23]
  v_add_u32 v48, 0x8000, v48
  global_load_dwordx4 v[116:119], v48, s[22:23]
  v_add_u32 v48, 0x8000, v48
  s_waitcnt vmcnt(11)
  v_lshrrev_b32 v49, 16, v20
  v_dot2c_f32_bf16 v40, v216, v49
  v_dot2c_f32_bf16 v41, v216, v20
  v_dot2c_f32_bf16 v42, v217, v49
  v_dot2c_f32_bf16 v43, v217, v20
  v_dot2c_f32_bf16 v44, v218, v49
  v_dot2c_f32_bf16 v45, v218, v20
  v_dot2c_f32_bf16 v46, v219, v49
  v_dot2c_f32_bf16 v47, v219, v20
  s_waitcnt vmcnt(10)
  v_lshrrev_b32 v49, 16, v21
  v_dot2c_f32_bf16 v40, v220, v49
  v_dot2c_f32_bf16 v41, v220, v21
  v_dot2c_f32_bf16 v42, v221, v49
  v_dot2c_f32_bf16 v43, v221, v21
  v_dot2c_f32_bf16 v44, v222, v49
  v_dot2c_f32_bf16 v45, v222, v21
  v_dot2c_f32_bf16 v46, v223, v49
  v_dot2c_f32_bf16 v47, v223, v21
  s_waitcnt vmcnt(9)
  v_lshrrev_b32 v49, 16, v22
  v_dot2c_f32_bf16 v40, v224, v49
  v_dot2c_f32_bf16 v41, v224, v22
  v_dot2c_f32_bf16 v42, v225, v49
  v_dot2c_f32_bf16 v43, v225, v22
  v_dot2c_f32_bf16 v44, v226, v49
  v_dot2c_f32_bf16 v45, v226, v22
  v_dot2c_f32_bf16 v46, v227, v49
  v_dot2c_f32_bf16 v47, v227, v22
  s_waitcnt vmcnt(8)
  s_add_u32 s7, s6, 163840
  s_add_u32 m0, s49, 21504
  s_nop 0
  buffer_load_dwordx4 v2, s[40:43], s7 offen offset:0 nt lds
  v_xor_b32 v51, 64, v2
  buffer_load_dwordx4 v51, s[40:43], s7 offen offset:1024 nt lds
  v_xor_b32 v50, 128, v2
  buffer_load_dwordx4 v50, s[40:43], s7 offen offset:2048 nt lds
  v_xor_b32 v51, 192, v2
  buffer_load_dwordx4 v51, s[40:43], s7 offen offset:3072 nt lds
  v_lshrrev_b32 v49, 16, v23
  v_dot2c_f32_bf16 v40, v228, v49
  v_dot2c_f32_bf16 v41, v228, v23
  v_dot2c_f32_bf16 v42, v229, v49
  v_dot2c_f32_bf16 v43, v229, v23
  v_dot2c_f32_bf16 v44, v230, v49
  v_dot2c_f32_bf16 v45, v230, v23
  v_dot2c_f32_bf16 v46, v231, v49
  v_dot2c_f32_bf16 v47, v231, v23
  s_waitcnt vmcnt(8)
  ds_read_b128 a[144:147], v52 offset:17408
  ds_read_b128 a[148:151], v53 offset:17408
  ds_read_b128 a[152:155], v54 offset:17408
  ds_read_b128 a[156:159], v55 offset:17408
  s_waitcnt lgkmcnt(0)
  global_load_dwordx4 v[120:123], v48, s[22:23]
  v_add_u32 v48, 0x8000, v48
  global_load_dwordx4 v[124:127], v48, s[22:23]
  v_add_u32 v48, 0x8000, v48
  global_load_dwordx4 v[128:131], v48, s[22:23]
  v_add_u32 v48, 0x8000, v48
  global_load_dwordx4 v[132:135], v48, s[22:23]
  v_add_u32 v48, 0x8000, v48
  s_waitcnt vmcnt(11)
  v_lshrrev_b32 v49, 16, v24
  v_dot2c_f32_bf16 v40, v104, v49
  v_dot2c_f32_bf16 v41, v104, v24
  v_dot2c_f32_bf16 v42, v105, v49
  v_dot2c_f32_bf16 v43, v105, v24
  v_dot2c_f32_bf16 v44, v106, v49
  v_dot2c_f32_bf16 v45, v106, v24
  v_dot2c_f32_bf16 v46, v107, v49
  v_dot2c_f32_bf16 v47, v107, v24
  s_waitcnt vmcnt(10)
  v_lshrrev_b32 v49, 16, v25
  v_dot2c_f32_bf16 v40, v108, v49
  v_dot2c_f32_bf16 v41, v108, v25
  v_dot2c_f32_bf16 v42, v109, v49
  v_dot2c_f32_bf16 v43, v109, v25
  v_dot2c_f32_bf16 v44, v110, v49
  v_dot2c_f32_bf16 v45, v110, v25
  v_dot2c_f32_bf16 v46, v111, v49
  v_dot2c_f32_bf16 v47, v111, v25
  s_waitcnt vmcnt(9)
  v_lshrrev_b32 v49, 16, v26
  v_dot2c_f32_bf16 v40, v112, v49
  v_dot2c_f32_bf16 v41, v112, v26
  v_dot2c_f32_bf16 v42, v113, v49
  v_dot2c_f32_bf16 v43, v113, v26
  v_dot2c_f32_bf16 v44, v114, v49
  v_dot2c_f32_bf16 v45, v114, v26
  v_dot2c_f32_bf16 v46, v115, v49
  v_dot2c_f32_bf16 v47, v115, v26
  s_waitcnt vmcnt(8)
  s_add_u32 s7, s6, 180224
  s_add_u32 m0, s49, 25600
  s_nop 0
  buffer_load_dwordx4 v2, s[40:43], s7 offen offset:0 nt lds
  v_xor_b32 v51, 64, v2
  buffer_load_dwordx4 v51, s[40:43], s7 offen offset:1024 nt lds
  v_xor_b32 v50, 128, v2
  buffer_load_dwordx4 v50, s[40:43], s7 offen offset:2048 nt lds
  v_xor_b32 v51, 192, v2
  buffer_load_dwordx4 v51, s[40:43], s7 offen offset:3072 nt lds
  v_lshrrev_b32 v49, 16, v27
  v_dot2c_f32_bf16 v40, v116, v49
  v_dot2c_f32_bf16 v41, v116, v27
  v_dot2c_f32_bf16 v42, v117, v49
  v_dot2c_f32_bf16 v43, v117, v27
  v_dot2c_f32_bf16 v44, v118, v49
  v_dot2c_f32_bf16 v45, v118, v27
  v_dot2c_f32_bf16 v46, v119, v49
  v_dot2c_f32_bf16 v47, v119, v27
  s_waitcnt vmcnt(8)
  ds_read_b128 a[160:163], v52 offset:21504
  ds_read_b128 a[164:167], v53 offset:21504
  ds_read_b128 a[168:171], v54 offset:21504
  ds_read_b128 a[172:175], v55 offset:21504
  s_waitcnt lgkmcnt(0)
  global_load_dwordx4 v[136:139], v48, s[22:23]
  v_add_u32 v48, 0x8000, v48
  global_load_dwordx4 v[140:143], v48, s[22:23]
  v_add_u32 v48, 0x8000, v48
  global_load_dwordx4 v[144:147], v48, s[22:23]
  v_add_u32 v48, 0x8000, v48
  global_load_dwordx4 v[148:151], v48, s[22:23]
  v_add_u32 v48, 0x8000, v48
  s_waitcnt vmcnt(11)
  v_lshrrev_b32 v49, 16, v28
  v_dot2c_f32_bf16 v40, v120, v49
  v_dot2c_f32_bf16 v41, v120, v28
  v_dot2c_f32_bf16 v42, v121, v49
  v_dot2c_f32_bf16 v43, v121, v28
  v_dot2c_f32_bf16 v44, v122, v49
  v_dot2c_f32_bf16 v45, v122, v28
  v_dot2c_f32_bf16 v46, v123, v49
  v_dot2c_f32_bf16 v47, v123, v28
  s_waitcnt vmcnt(10)
  v_lshrrev_b32 v49, 16, v29
  v_dot2c_f32_bf16 v40, v124, v49
  v_dot2c_f32_bf16 v41, v124, v29
  v_dot2c_f32_bf16 v42, v125, v49
  v_dot2c_f32_bf16 v43, v125, v29
  v_dot2c_f32_bf16 v44, v126, v49
  v_dot2c_f32_bf16 v45, v126, v29
  v_dot2c_f32_bf16 v46, v127, v49
  v_dot2c_f32_bf16 v47, v127, v29
  s_waitcnt vmcnt(9)
  v_lshrrev_b32 v49, 16, v30
  v_dot2c_f32_bf16 v40, v128, v49
  v_dot2c_f32_bf16 v41, v128, v30
  v_dot2c_f32_bf16 v42, v129, v49
  v_dot2c_f32_bf16 v43, v129, v30
  v_dot2c_f32_bf16 v44, v130, v49
  v_dot2c_f32_bf16 v45, v130, v30
  v_dot2c_f32_bf16 v46, v131, v49
  v_dot2c_f32_bf16 v47, v131, v30
  s_waitcnt vmcnt(8)
  s_add_u32 s7, s6, 196608
  s_add_u32 m0, s49, 29696
  s_nop 0
  buffer_load_dwordx4 v2, s[40:43], s7 offen offset:0 nt lds
  v_xor_b32 v51, 64, v2
  buffer_load_dwordx4 v51, s[40:43], s7 offen offset:1024 nt lds
  v_xor_b32 v50, 128, v2
  buffer_load_dwordx4 v50, s[40:43], s7 offen offset:2048 nt lds
  v_xor_b32 v51, 192, v2
  buffer_load_dwordx4 v51, s[40:43], s7 offen offset:3072 nt lds
  v_lshrrev_b32 v49, 16, v31
  v_dot2c_f32_bf16 v40, v132, v49
  v_dot2c_f32_bf16 v41, v132, v31
  v_dot2c_f32_bf16 v42, v133, v49
  v_dot2c_f32_bf16 v43, v133, v31
  v_dot2c_f32_bf16 v44, v134, v49
  v_dot2c_f32_bf16 v45, v134, v31
  v_dot2c_f32_bf16 v46, v135, v49
  v_dot2c_f32_bf16 v47, v135, v31
  s_waitcnt vmcnt(8)
  ds_read_b128 a[176:179], v52 offset:25600
  ds_read_b128 a[180:183], v53 offset:25600
  ds_read_b128 a[184:187], v54 offset:25600
  ds_read_b128 a[188:191], v55 offset:25600
  s_waitcnt lgkmcnt(0)
  global_load_dwordx4 v[152:155], v48, s[22:23]
  v_add_u32 v48, 0x8000, v48
  global_load_dwordx4 v[156:159], v48, s[22:23]
  v_add_u32 v48, 0x8000, v48
  global_load_dwordx4 v[160:163], v48, s[22:23]
  v_add_u32 v48, 0x8000, v48
  global_load_dwordx4 v[164:167], v48, s[22:23]
  s_waitcnt vmcnt(11)
  v_lshrrev_b32 v49, 16, v32
  v_dot2c_f32_bf16 v40, v136, v49
  v_dot2c_f32_bf16 v41, v136, v32
  v_dot2c_f32_bf16 v42, v137, v49
  v_dot2c_f32_bf16 v43, v137, v32
  v_dot2c_f32_bf16 v44, v138, v49
  v_dot2c_f32_bf16 v45, v138, v32
  v_dot2c_f32_bf16 v46, v139, v49
  v_dot2c_f32_bf16 v47, v139, v32
  s_waitcnt vmcnt(10)
  v_lshrrev_b32 v49, 16, v33
  v_dot2c_f32_bf16 v40, v140, v49
  v_dot2c_f32_bf16 v41, v140, v33
  v_dot2c_f32_bf16 v42, v141, v49
  v_dot2c_f32_bf16 v43, v141, v33
  v_dot2c_f32_bf16 v44, v142, v49
  v_dot2c_f32_bf16 v45, v142, v33
  v_dot2c_f32_bf16 v46, v143, v49
  v_dot2c_f32_bf16 v47, v143, v33
  s_waitcnt vmcnt(9)
  v_lshrrev_b32 v49, 16, v34
  v_dot2c_f32_bf16 v40, v144, v49
  v_dot2c_f32_bf16 v41, v144, v34
  v_dot2c_f32_bf16 v42, v145, v49
  v_dot2c_f32_bf16 v43, v145, v34
  v_dot2c_f32_bf16 v44, v146, v49
  v_dot2c_f32_bf16 v45, v146, v34
  v_dot2c_f32_bf16 v46, v147, v49
  v_dot2c_f32_bf16 v47, v147, v34
  s_waitcnt vmcnt(8)
  s_add_u32 s7, s6, 212992
  s_add_u32 m0, s49, 33792
  s_nop 0
  buffer_load_dwordx4 v2, s[40:43], s7 offen offset:0 nt lds
  v_xor_b32 v51, 64, v2
  buffer_load_dwordx4 v51, s[40:43], s7 offen offset:1024 nt lds
  v_xor_b32 v50, 128, v2
  buffer_load_dwordx4 v50, s[40:43], s7 offen offset:2048 nt lds
  v_xor_b32 v51, 192, v2
  buffer_load_dwordx4 v51, s[40:43], s7 offen offset:3072 nt lds
  v_lshrrev_b32 v49, 16, v35
  v_dot2c_f32_bf16 v40, v148, v49
  v_dot2c_f32_bf16 v41, v148, v35
  v_dot2c_f32_bf16 v42, v149, v49
  v_dot2c_f32_bf16 v43, v149, v35
  v_dot2c_f32_bf16 v44, v150, v49
  v_dot2c_f32_bf16 v45, v150, v35
  v_dot2c_f32_bf16 v46, v151, v49
  v_dot2c_f32_bf16 v47, v151, v35
  s_waitcnt vmcnt(8)
  ds_read_b128 a[192:195], v52 offset:29696
  ds_read_b128 a[196:199], v53 offset:29696
  ds_read_b128 a[200:203], v54 offset:29696
  ds_read_b128 a[204:207], v55 offset:29696
  s_waitcnt lgkmcnt(0)
  s_waitcnt vmcnt(7)
  v_lshrrev_b32 v49, 16, v36
  v_dot2c_f32_bf16 v40, v152, v49
  v_dot2c_f32_bf16 v41, v152, v36
  v_dot2c_f32_bf16 v42, v153, v49
  v_dot2c_f32_bf16 v43, v153, v36
  v_dot2c_f32_bf16 v44, v154, v49
  v_dot2c_f32_bf16 v45, v154, v36
  v_dot2c_f32_bf16 v46, v155, v49
  v_dot2c_f32_bf16 v47, v155, v36
  s_waitcnt vmcnt(6)
  v_lshrrev_b32 v49, 16, v37
  v_dot2c_f32_bf16 v40, v156, v49
  v_dot2c_f32_bf16 v41, v156, v37
  v_dot2c_f32_bf16 v42, v157, v49
  v_dot2c_f32_bf16 v43, v157, v37
  v_dot2c_f32_bf16 v44, v158, v49
  v_dot2c_f32_bf16 v45, v158, v37
  v_dot2c_f32_bf16 v46, v159, v49
  v_dot2c_f32_bf16 v47, v159, v37
  s_waitcnt vmcnt(5)
  v_lshrrev_b32 v49, 16, v38
  v_dot2c_f32_bf16 v40, v160, v49
  v_dot2c_f32_bf16 v41, v160, v38
  v_dot2c_f32_bf16 v42, v161, v49
  v_dot2c_f32_bf16 v43, v161, v38
  v_dot2c_f32_bf16 v44, v162, v49
  v_dot2c_f32_bf16 v45, v162, v38
  v_dot2c_f32_bf16 v46, v163, v49
  v_dot2c_f32_bf16 v47, v163, v38
  s_waitcnt vmcnt(4)
  v_lshrrev_b32 v49, 16, v39
  v_dot2c_f32_bf16 v40, v164, v49
  v_dot2c_f32_bf16 v41, v164, v39
  v_dot2c_f32_bf16 v42, v165, v49
  v_dot2c_f32_bf16 v43, v165, v39
  v_dot2c_f32_bf16 v44, v166, v49
  v_dot2c_f32_bf16 v45, v166, v39
  v_dot2c_f32_bf16 v46, v167, v49
  v_dot2c_f32_bf16 v47, v167, v39
  s_add_u32 s7, s6, 229376
  s_add_u32 m0, s49, 1024
  s_nop 0
  buffer_load_dwordx4 v2, s[40:43], s7 offen offset:0 nt lds
  v_xor_b32 v51, 64, v2
  buffer_load_dwordx4 v51, s[40:43], s7 offen offset:1024 nt lds
  v_xor_b32 v50, 128, v2
  buffer_load_dwordx4 v50, s[40:43], s7 offen offset:2048 nt lds
  v_xor_b32 v51, 192, v2
  buffer_load_dwordx4 v51, s[40:43], s7 offen offset:3072 nt lds
  s_add_u32 s7, s6, 245760
  s_add_u32 m0, s49, 5120
  s_nop 0
  buffer_load_dwordx4 v2, s[40:43], s7 offen offset:0 nt lds
  v_xor_b32 v51, 64, v2
  buffer_load_dwordx4 v51, s[40:43], s7 offen offset:1024 nt lds
  v_xor_b32 v50, 128, v2
  buffer_load_dwordx4 v50, s[40:43], s7 offen offset:2048 nt lds
  v_xor_b32 v51, 192, v2
  buffer_load_dwordx4 v51, s[40:43], s7 offen offset:3072 nt lds
  v_permlane32_swap_b32 v40, v44
  v_permlane32_swap_b32 v41, v45
  v_permlane32_swap_b32 v42, v46
  v_permlane32_swap_b32 v43, v47
  v_add_f32 v40, v40, v44
  v_add_f32 v41, v41, v45
  v_add_f32 v42, v42, v46
  v_add_f32 v43, v43, v47
  s_nop 0
  v_permlane16_swap_b32 v40, v42
  v_permlane16_swap_b32 v41, v43
  v_add_f32 v40, v40, v42
  v_add_f32 v41, v41, v43
  v_and_b32 v4, 15, v0
  v_lshlrev_b32 v4, 5, v4
  v_lshrrev_b32 v5, 4, v0
  v_lshl_add_u32 v4, v5, 3, v4
  s_lshl_b32 s12, s3, 9
  v_add_u32 v4, s12, v4
  ds_write_b64 v4, v[40:41] offset:4096
  s_waitcnt lgkmcnt(0)
  s_barrier
  v_lshlrev_b32 v7, 3, v0
  ds_read_b64 v[40:41], v7 offset:4096
  ds_read_b64 v[42:43], v7 offset:4608
  ds_read_b64 v[44:45], v7 offset:5120
  ds_read_b64 v[46:47], v7 offset:5632
  s_waitcnt lgkmcnt(0)
  v_add_f32 v40, v40, v42
  v_add_f32 v41, v41, v43
  v_add_f32 v44, v44, v46
  v_add_f32 v45, v45, v47
  v_add_f32 v40, v40, v44
  v_add_f32 v41, v41, v45
  v_cvt_pk_bf16_f32 v40, v40, v41
  v_lshlrev_b32 v4, 2, v0
  s_lshl_b32 s12, s3, 8
  v_add_u32 v4, s12, v4
  ds_write_b32 v4, v40 offset:6144
  v_lshrrev_b32 v4, 4, v0
  v_lshlrev_b32 v4, 4, v4
  v_add_u32 v4, s12, v4
  s_waitcnt lgkmcnt(0)
  ds_read_b128 v[8:11], v4 offset:6144
  ds_read_b128 v[12:15], v4 offset:6208
  ds_read_b128 v[16:19], v4 offset:6272
  ds_read_b128 v[20:23], v4 offset:6336
  s_waitcnt lgkmcnt(0)
  s_barrier
  v_add_u32 v7, s49, v3
  v_lshrrev_b32 v6, 4, v0
  v_lshlrev_b32 v6, 4, v6
  s_lshl_b32 s12, s3, 11
  v_add_u32 v6, s12, v6
  v_mfma_f32_16x16x32_bf16 v[24:27], a[0:3], v[8:11], 0
  v_mfma_f32_16x16x32_bf16 v[24:27], a[4:7], v[12:15], v[24:27]
  v_mfma_f32_16x16x32_bf16 v[24:27], a[8:11], v[16:19], v[24:27]
  v_mfma_f32_16x16x32_bf16 v[24:27], a[12:15], v[20:23], v[24:27]
  v_mfma_f32_16x16x32_bf16 v[28:31], a[16:19], v[8:11], 0
  v_mfma_f32_16x16x32_bf16 v[28:31], a[20:23], v[12:15], v[28:31]
  v_mfma_f32_16x16x32_bf16 v[28:31], a[24:27], v[16:19], v[28:31]
  v_mfma_f32_16x16x32_bf16 v[28:31], a[28:31], v[20:23], v[28:31]
  s_mov_b64 exec, s[52:53]
  s_nop 2
  ds_write_b128 v6, v[24:27] offset:0
  s_mov_b64 exec, -1
  v_mfma_f32_16x16x32_bf16 v[24:27], a[32:35], v[8:11], 0
  v_mfma_f32_16x16x32_bf16 v[24:27], a[36:39], v[12:15], v[24:27]
  v_mfma_f32_16x16x32_bf16 v[24:27], a[40:43], v[16:19], v[24:27]
  v_mfma_f32_16x16x32_bf16 v[24:27], a[44:47], v[20:23], v[24:27]
  s_mov_b64 exec, s[52:53]
  ds_write_b128 v6, v[28:31] offset:64
  s_mov_b64 exec, -1
  v_mfma_f32_16x16x32_bf16 v[28:31], a[48:51], v[8:11], 0
  v_mfma_f32_16x16x32_bf16 v[28:31], a[52:55], v[12:15], v[28:31]
  v_mfma_f32_16x16x32_bf16 v[28:31], a[56:59], v[16:19], v[28:31]
  v_mfma_f32_16x16x32_bf16 v[28:31], a[60:63], v[20:23], v[28:31]
  s_mov_b64 exec, s[52:53]
  ds_write_b128 v6, v[24:27] offset:128
  s_mov_b64 exec, -1
  v_mfma_f32_16x16x32_bf16 v[24:27], a[64:67], v[8:11], 0
  v_mfma_f32_16x16x32_bf16 v[24:27], a[68:71], v[12:15], v[24:27]
  v_mfma_f32_16x16x32_bf16 v[24:27], a[72:75], v[16:19], v[24:27]
  v_mfma_f32_16x16x32_bf16 v[24:27], a[76:79], v[20:23], v[24:27]
  s_mov_b64 exec, s[52:53]
  ds_write_b128 v6, v[28:31] offset:192
  s_mov_b64 exec, -1
  v_mfma_f32_16x16x32_bf16 v[28:31], a[80:83], v[8:11], 0
  v_mfma_f32_16x16x32_bf16 v[28:31], a[84:87], v[12:15], v[28:31]
  v_mfma_f32_16x16x32_bf16 v[28:31], a[88:91], v[16:19], v[28:31]
  v_mfma_f32_16x16x32_bf16 v[28:31], a[92:95], v[20:23], v[28:31]
  s_mov_b64 exec, s[52:53]
  ds_write_b128 v6, v[24:27] offset:256
  s_mov_b64 exec, -1
  v_mfma_f32_16x16x32_bf16 v[24:27], a[96:99], v[8:11], 0
  v_mfma_f32_16x16x32_bf16 v[24:27], a[100:103], v[12:15], v[24:27]
  v_mfma_f32_16x16x32_bf16 v[24:27], a[104:107], v[16:19], v[24:27]
  v_mfma_f32_16x16x32_bf16 v[24:27], a[108:111], v[20:23], v[24:27]
  s_mov_b64 exec, s[52:53]
  ds_write_b128 v6, v[28:31] offset:320
  s_mov_b64 exec, -1
  v_mfma_f32_16x16x32_bf16 v[28:31], a[112:115], v[8:11], 0
  v_mfma_f32_16x16x32_bf16 v[28:31], a[116:119], v[12:15], v[28:31]
  v_mfma_f32_16x16x32_bf16 v[28:31], a[120:123], v[16:19], v[28:31]
  v_mfma_f32_16x16x32_bf16 v[28:31], a[124:127], v[20:23], v[28:31]
  s_mov_b64 exec, s[52:53]
  ds_write_b128 v6, v[24:27] offset:384
  s_mov_b64 exec, -1
  v_mfma_f32_16x16x32_bf16 v[24:27], a[128:131], v[8:11], 0
  v_mfma_f32_16x16x32_bf16 v[24:27], a[132:135], v[12:15], v[24:27]
  v_mfma_f32_16x16x32_bf16 v[24:27], a[136:139], v[16:19], v[24:27]
  v_mfma_f32_16x16x32_bf16 v[24:27], a[140:143], v[20:23], v[24:27]
  s_mov_b64 exec, s[52:53]
  ds_write_b128 v6, v[28:31] offset:448
  s_mov_b64 exec, -1
  v_mfma_f32_16x16x32_bf16 v[28:31], a[144:147], v[8:11], 0
  v_mfma_f32_16x16x32_bf16 v[28:31], a[148:151], v[12:15], v[28:31]
  v_mfma_f32_16x16x32_bf16 v[28:31], a[152:155], v[16:19], v[28:31]
  v_mfma_f32_16x16x32_bf16 v[28:31], a[156:159], v[20:23], v[28:31]
  s_mov_b64 exec, s[52:53]
  ds_write_b128 v6, v[24:27] offset:512
  s_mov_b64 exec, -1
  v_mfma_f32_16x16x32_bf16 v[24:27], a[160:163], v[8:11], 0
  v_mfma_f32_16x16x32_bf16 v[24:27], a[164:167], v[12:15], v[24:27]
  v_mfma_f32_16x16x32_bf16 v[24:27], a[168:171], v[16:19], v[24:27]
  v_mfma_f32_16x16x32_bf16 v[24:27], a[172:175], v[20:23], v[24:27]
  s_mov_b64 exec, s[52:53]
  ds_write_b128 v6, v[28:31] offset:576
  s_mov_b64 exec, -1
  v_mfma_f32_16x16x32_bf16 v[28:31], a[176:179], v[8:11], 0
  v_mfma_f32_16x16x32_bf16 v[28:31], a[180:183], v[12:15], v[28:31]
  v_mfma_f32_16x16x32_bf16 v[28:31], a[184:187], v[16:19], v[28:31]
  v_mfma_f32_16x16x32_bf16 v[28:31], a[188:191], v[20:23], v[28:31]
  s_mov_b64 exec, s[52:53]
  ds_write_b128 v6, v[24:27] offset:640
  s_mov_b64 exec, -1
  v_mfma_f32_16x16x32_bf16 v[24:27], a[192:195], v[8:11], 0
  v_mfma_f32_16x16x32_bf16 v[24:27], a[196:199], v[12:15], v[24:27]
  v_mfma_f32_16x16x32_bf16 v[24:27], a[200:203], v[16:19], v[24:27]
  v_mfma_f32_16x16x32_bf16 v[24:27], a[204:207], v[20:23], v[24:27]
  s_mov_b64 exec, s[52:53]
  ds_write_b128 v6, v[28:31] offset:704
  s_mov_b64 exec, -1
  s_waitcnt vmcnt(8)
  ds_read_b128 a[208:211], v52 offset:33792
  ds_read_b128 a[212:215], v53 offset:33792
  ds_read_b128 a[216:219], v54 offset:33792
  ds_read_b128 a[220:223], v55 offset:33792
  s_waitcnt lgkmcnt(0)
  v_mfma_f32_16x16x32_bf16 v[28:31], a[208:211], v[8:11], 0
  v_mfma_f32_16x16x32_bf16 v[28:31], a[212:215], v[12:15], v[28:31]
  v_mfma_f32_16x16x32_bf16 v[28:31], a[216:219], v[16:19], v[28:31]
  v_mfma_f32_16x16x32_bf16 v[28:31], a[220:223], v[20:23], v[28:31]
  s_mov_b64 exec, s[52:53]
  ds_write_b128 v6, v[24:27] offset:768
  s_mov_b64 exec, -1
  s_waitcnt vmcnt(4)
  ds_read_b128 a[224:227], v52 offset:1024
  ds_read_b128 a[228:231], v53 offset:1024
  ds_read_b128 a[232:235], v54 offset:1024
  ds_read_b128 a[236:239], v55 offset:1024
  s_waitcnt lgkmcnt(0)
  v_mfma_f32_16x16x32_bf16 v[24:27], a[224:227], v[8:11], 0
  s_add_u32 s7, s6, 262144
  s_add_u32 m0, s49, 9216
  s_nop 0
  buffer_load_dwordx4 v2, s[40:43], s7 offen offset:0 nt lds
  v_xor_b32 v51, 64, v2
  buffer_load_dwordx4 v51, s[40:43], s7 offen offset:1024 nt lds
  v_xor_b32 v50, 128, v2
  buffer_load_dwordx4 v50, s[40:43], s7 offen offset:2048 nt lds
  v_xor_b32 v51, 192, v2
  buffer_load_dwordx4 v51, s[40:43], s7 offen offset:3072 nt lds
  v_mfma_f32_16x16x32_bf16 v[24:27], a[228:231], v[12:15], v[24:27]
  v_mfma_f32_16x16x32_bf16 v[24:27], a[232:235], v[16:19], v[24:27]
  v_mfma_f32_16x16x32_bf16 v[24:27], a[236:239], v[20:23], v[24:27]
  s_mov_b64 exec, s[52:53]
  ds_write_b128 v6, v[28:31] offset:832
  s_mov_b64 exec, -1
  s_waitcnt vmcnt(4)
  ds_read_b128 a[240:243], v52 offset:5120
  ds_read_b128 a[244:247], v53 offset:5120
  ds_read_b128 a[248:251], v54 offset:5120
  ds_read_b128 a[252:255], v55 offset:5120
  s_waitcnt lgkmcnt(0)
  v_mfma_f32_16x16x32_bf16 v[28:31], a[240:243], v[8:11], 0
  s_add_u32 s7, s6, 278528
  s_add_u32 m0, s49, 13312
  s_nop 0
  buffer_load_dwordx4 v2, s[40:43], s7 offen offset:0 nt lds
  v_xor_b32 v51, 64, v2
  buffer_load_dwordx4 v51, s[40:43], s7 offen offset:1024 nt lds
  v_xor_b32 v50, 128, v2
  buffer_load_dwordx4 v50, s[40:43], s7 offen offset:2048 nt lds
  v_xor_b32 v51, 192, v2
  buffer_load_dwordx4 v51, s[40:43], s7 offen offset:3072 nt lds
  v_mfma_f32_16x16x32_bf16 v[28:31], a[244:247], v[12:15], v[28:31]
  v_mfma_f32_16x16x32_bf16 v[28:31], a[248:251], v[16:19], v[28:31]
  v_mfma_f32_16x16x32_bf16 v[28:31], a[252:255], v[20:23], v[28:31]
  s_mov_b64 exec, s[52:53]
  ds_write_b128 v6, v[24:27] offset:896
  s_mov_b64 exec, -1
  s_waitcnt vmcnt(4)
  ds_read_b128 v[56:59], v52 offset:9216
  ds_read_b128 v[60:63], v53 offset:9216
  ds_read_b128 v[64:67], v54 offset:9216
  ds_read_b128 v[68:71], v55 offset:9216
  s_waitcnt lgkmcnt(0)
  v_mfma_f32_16x16x32_bf16 v[24:27], v[56:59], v[8:11], 0
  s_add_u32 s7, s6, 294912
  s_add_u32 m0, s49, 17408
  s_nop 0
  buffer_load_dwordx4 v2, s[40:43], s7 offen offset:0 nt lds
  v_xor_b32 v51, 64, v2
  buffer_load_dwordx4 v51, s[40:43], s7 offen offset:1024 nt lds
  v_xor_b32 v50, 128, v2
  buffer_load_dwordx4 v50, s[40:43], s7 offen offset:2048 nt lds
  v_xor_b32 v51, 192, v2
  buffer_load_dwordx4 v51, s[40:43], s7 offen offset:3072 nt lds
  v_mfma_f32_16x16x32_bf16 v[24:27], v[60:63], v[12:15], v[24:27]
  v_mfma_f32_16x16x32_bf16 v[24:27], v[64:67], v[16:19], v[24:27]
  v_mfma_f32_16x16x32_bf16 v[24:27], v[68:71], v[20:23], v[24:27]
  s_mov_b64 exec, s[52:53]
  ds_write_b128 v6, v[28:31] offset:960
  s_mov_b64 exec, -1
  s_waitcnt vmcnt(4)
  ds_read_b128 v[72:75], v52 offset:13312
  ds_read_b128 v[76:79], v53 offset:13312
  ds_read_b128 v[80:83], v54 offset:13312
  ds_read_b128 v[84:87], v55 offset:13312
  s_waitcnt lgkmcnt(0)
  v_mfma_f32_16x16x32_bf16 v[28:31], v[72:75], v[8:11], 0
  s_add_u32 s7, s6, 311296
  s_add_u32 m0, s49, 21504
  s_nop 0
  buffer_load_dwordx4 v2, s[40:43], s7 offen offset:0 nt lds
  v_xor_b32 v51, 64, v2
  buffer_load_dwordx4 v51, s[40:43], s7 offen offset:1024 nt lds
  v_xor_b32 v50, 128, v2
  buffer_load_dwordx4 v50, s[40:43], s7 offen offset:2048 nt lds
  v_xor_b32 v51, 192, v2
  buffer_load_dwordx4 v51, s[40:43], s7 offen offset:3072 nt lds
  v_mfma_f32_16x16x32_bf16 v[28:31], v[76:79], v[12:15], v[28:31]
  v_mfma_f32_16x16x32_bf16 v[28:31], v[80:83], v[16:19], v[28:31]
  v_mfma_f32_16x16x32_bf16 v[28:31], v[84:87], v[20:23], v[28:31]
  s_mov_b64 exec, s[52:53]
  ds_write_b128 v6, v[24:27] offset:1024
  s_mov_b64 exec, -1
  s_waitcnt vmcnt(4)
  ds_read_b128 v[88:91], v52 offset:17408
  ds_read_b128 v[92:95], v53 offset:17408
  ds_read_b128 v[96:99], v54 offset:17408
  ds_read_b128 v[100:103], v55 offset:17408
  s_waitcnt lgkmcnt(0)
  v_mfma_f32_16x16x32_bf16 v[24:27], v[88:91], v[8:11], 0
  s_add_u32 s7, s6, 327680
  s_add_u32 m0, s49, 25600
  s_nop 0
  buffer_load_dwordx4 v2, s[40:43], s7 offen offset:0 nt lds
  v_xor_b32 v51, 64, v2
  buffer_load_dwordx4 v51, s[40:43], s7 offen offset:1024 nt lds
  v_xor_b32 v50, 128, v2
  buffer_load_dwordx4 v50, s[40:43], s7 offen offset:2048 nt lds
  v_xor_b32 v51, 192, v2
  buffer_load_dwordx4 v51, s[40:43], s7 offen offset:3072 nt lds
  v_mfma_f32_16x16x32_bf16 v[24:27], v[92:95], v[12:15], v[24:27]
  v_mfma_f32_16x16x32_bf16 v[24:27], v[96:99], v[16:19], v[24:27]
  v_mfma_f32_16x16x32_bf16 v[24:27], v[100:103], v[20:23], v[24:27]
  s_mov_b64 exec, s[52:53]
  ds_write_b128 v6, v[28:31] offset:1088
  s_mov_b64 exec, -1
  s_waitcnt vmcnt(4)
  ds_read_b128 v[104:107], v52 offset:21504
  ds_read_b128 v[108:111], v53 offset:21504
  ds_read_b128 v[112:115], v54 offset:21504
  ds_read_b128 v[116:119], v55 offset:21504
  s_waitcnt lgkmcnt(0)
  v_mfma_f32_16x16x32_bf16 v[28:31], v[104:107], v[8:11], 0
  s_add_u32 s7, s6, 344064
  s_add_u32 m0, s49, 29696
  s_nop 0
  buffer_load_dwordx4 v2, s[40:43], s7 offen offset:0 nt lds
  v_xor_b32 v51, 64, v2
  buffer_load_dwordx4 v51, s[40:43], s7 offen offset:1024 nt lds
  v_xor_b32 v50, 128, v2
  buffer_load_dwordx4 v50, s[40:43], s7 offen offset:2048 nt lds
  v_xor_b32 v51, 192, v2
  buffer_load_dwordx4 v51, s[40:43], s7 offen offset:3072 nt lds
  v_mfma_f32_16x16x32_bf16 v[28:31], v[108:111], v[12:15], v[28:31]
  v_mfma_f32_16x16x32_bf16 v[28:31], v[112:115], v[16:19], v[28:31]
  v_mfma_f32_16x16x32_bf16 v[28:31], v[116:119], v[20:23], v[28:31]
  s_mov_b64 exec, s[52:53]
  ds_write_b128 v6, v[24:27] offset:1152
  s_mov_b64 exec, -1
  s_waitcnt vmcnt(4)
  ds_read_b128 v[120:123], v52 offset:25600
  ds_read_b128 v[124:127], v53 offset:25600
  ds_read_b128 v[128:131], v54 offset:25600
  ds_read_b128 v[132:135], v55 offset:25600
  s_waitcnt lgkmcnt(0)
  v_mfma_f32_16x16x32_bf16 v[24:27], v[120:123], v[8:11], 0
  s_add_u32 s7, s6, 360448
  s_add_u32 m0, s49, 33792
  s_nop 0
  buffer_load_dwordx4 v2, s[40:43], s7 offen offset:0 nt lds
  v_xor_b32 v51, 64, v2
  buffer_load_dwordx4 v51, s[40:43], s7 offen offset:1024 nt lds
  v_xor_b32 v50, 128, v2
  buffer_load_dwordx4 v50, s[40:43], s7 offen offset:2048 nt lds
  v_xor_b32 v51, 192, v2
  buffer_load_dwordx4 v51, s[40:43], s7 offen offset:3072 nt lds
  v_mfma_f32_16x16x32_bf16 v[24:27], v[124:127], v[12:15], v[24:27]
  v_mfma_f32_16x16x32_bf16 v[24:27], v[128:131], v[16:19], v[24:27]
  v_mfma_f32_16x16x32_bf16 v[24:27], v[132:135], v[20:23], v[24:27]
  s_mov_b64 exec, s[52:53]
  ds_write_b128 v6, v[28:31] offset:1216
  s_mov_b64 exec, -1
  s_waitcnt vmcnt(4)
  ds_read_b128 v[136:139], v52 offset:29696
  ds_read_b128 v[140:143], v53 offset:29696
  ds_read_b128 v[144:147], v54 offset:29696
  ds_read_b128 v[148:151], v55 offset:29696
  s_waitcnt lgkmcnt(0)
  v_mfma_f32_16x16x32_bf16 v[28:31], v[136:139], v[8:11], 0
  s_add_u32 s7, s6, 376832
  s_add_u32 m0, s49, 1024
  s_nop 0
  buffer_load_dwordx4 v2, s[40:43], s7 offen offset:0 nt lds
  v_xor_b32 v51, 64, v2
  buffer_load_dwordx4 v51, s[40:43], s7 offen offset:1024 nt lds
  v_xor_b32 v50, 128, v2
  buffer_load_dwordx4 v50, s[40:43], s7 offen offset:2048 nt lds
  v_xor_b32 v51, 192, v2
  buffer_load_dwordx4 v51, s[40:43], s7 offen offset:3072 nt lds
  v_mfma_f32_16x16x32_bf16 v[28:31], v[140:143], v[12:15], v[28:31]
  v_mfma_f32_16x16x32_bf16 v[28:31], v[144:147], v[16:19], v[28:31]
  v_mfma_f32_16x16x32_bf16 v[28:31], v[148:151], v[20:23], v[28:31]
  s_mov_b64 exec, s[52:53]
  ds_write_b128 v6, v[24:27] offset:1280
  s_mov_b64 exec, -1
  s_waitcnt vmcnt(4)
  ds_read_b128 v[152:155], v52 offset:33792
  ds_read_b128 v[156:159], v53 offset:33792
  ds_read_b128 v[160:163], v54 offset:33792
  ds_read_b128 v[164:167], v55 offset:33792
  s_waitcnt lgkmcnt(0)
  v_mfma_f32_16x16x32_bf16 v[24:27], v[152:155], v[8:11], 0
  s_add_u32 s7, s6, 393216
  s_add_u32 m0, s49, 5120
  s_nop 0
  buffer_load_dwordx4 v2, s[40:43], s7 offen offset:0 nt lds
  v_xor_b32 v51, 64, v2
  buffer_load_dwordx4 v51, s[40:43], s7 offen offset:1024 nt lds
  v_xor_b32 v50, 128, v2
  buffer_load_dwordx4 v50, s[40:43], s7 offen offset:2048 nt lds
  v_xor_b32 v51, 192, v2
  buffer_load_dwordx4 v51, s[40:43], s7 offen offset:3072 nt lds
  v_mfma_f32_16x16x32_bf16 v[24:27], v[156:159], v[12:15], v[24:27]
  v_mfma_f32_16x16x32_bf16 v[24:27], v[160:163], v[16:19], v[24:27]
  v_mfma_f32_16x16x32_bf16 v[24:27], v[164:167], v[20:23], v[24:27]
  s_barrier
  s_cmp_lg_u32 s3, 0
  s_cbranch_scc1 L_noatom_3
  s_and_b32 s12, s2, 7
  s_lshl_b32 s12, s12, 5
  s_mov_b64 exec, 1
  v_mov_b32 v4, s12
  v_mov_b32 v5, 1
  global_atomic_add v4, v5, s[36:37]
  s_mov_b64 exec, -1
L_noatom_3:
  s_mov_b64 exec, s[52:53]
  ds_write_b128 v6, v[28:31] offset:1344
  s_mov_b64 exec, -1
  s_waitcnt vmcnt(4)
  ds_read_b128 v[32:35], v52 offset:1024
  ds_read_b128 v[36:39], v53 offset:1024
  ds_read_b128 v[40:43], v54 offset:1024
  ds_read_b128 v[44:47], v55 offset:1024
  s_waitcnt lgkmcnt(0)
  v_mfma_f32_16x16x32_bf16 v[28:31], v[32:35], v[8:11], 0
  s_add_u32 s7, s6, 409600
  s_add_u32 m0, s49, 9216
  s_nop 0
  buffer_load_dwordx4 v2, s[40:43], s7 offen offset:0 nt lds
  v_xor_b32 v51, 64, v2
  buffer_load_dwordx4 v51, s[40:43], s7 offen offset:1024 nt lds
  v_xor_b32 v50, 128, v2
  buffer_load_dwordx4 v50, s[40:43], s7 offen offset:2048 nt lds
  v_xor_b32 v51, 192, v2
  buffer_load_dwordx4 v51, s[40:43], s7 offen offset:3072 nt lds
  v_mfma_f32_16x16x32_bf16 v[28:31], v[36:39], v[12:15], v[28:31]
  v_mfma_f32_16x16x32_bf16 v[28:31], v[40:43], v[16:19], v[28:31]
  v_mfma_f32_16x16x32_bf16 v[28:31], v[44:47], v[20:23], v[28:31]
  s_mov_b64 exec, s[52:53]
  ds_write_b128 v6, v[24:27] offset:1408
  s_mov_b64 exec, -1
  s_waitcnt vmcnt(4)
  ds_read_b128 v[32:35], v52 offset:5120
  ds_read_b128 v[36:39], v53 offset:5120
  ds_read_b128 v[40:43], v54 offset:5120
  ds_read_b128 v[44:47], v55 offset:5120
  s_waitcnt lgkmcnt(0)
  v_mfma_f32_16x16x32_bf16 v[24:27], v[32:35], v[8:11], 0
  s_add_u32 s7, s6, 425984
  s_add_u32 m0, s49, 13312
  s_nop 0
  buffer_load_dwordx4 v2, s[40:43], s7 offen offset:0 nt lds
  v_xor_b32 v51, 64, v2
  buffer_load_dwordx4 v51, s[40:43], s7 offen offset:1024 nt lds
  v_xor_b32 v50, 128, v2
  buffer_load_dwordx4 v50, s[40:43], s7 offen offset:2048 nt lds
  v_xor_b32 v51, 192, v2
  buffer_load_dwordx4 v51, s[40:43], s7 offen offset:3072 nt lds
  v_mfma_f32_16x16x32_bf16 v[24:27], v[36:39], v[12:15], v[24:27]
  v_mfma_f32_16x16x32_bf16 v[24:27], v[40:43], v[16:19], v[24:27]
  v_mfma_f32_16x16x32_bf16 v[24:27], v[44:47], v[20:23], v[24:27]
  s_mov_b64 exec, s[52:53]
  ds_write_b128 v6, v[28:31] offset:1472
  s_mov_b64 exec, -1
  s_waitcnt vmcnt(4)
  ds_read_b128 v[32:35], v52 offset:9216
  ds_read_b128 v[36:39], v53 offset:9216
  ds_read_b128 v[40:43], v54 offset:9216
  ds_read_b128 v[44:47], v55 offset:9216
  s_waitcnt lgkmcnt(0)
  v_mfma_f32_16x16x32_bf16 v[28:31], v[32:35], v[8:11], 0
  s_add_u32 s7, s6, 442368
  s_add_u32 m0, s49, 17408
  s_nop 0
  buffer_load_dwordx4 v2, s[40:43], s7 offen offset:0 nt lds
  v_xor_b32 v51, 64, v2
  buffer_load_dwordx4 v51, s[40:43], s7 offen offset:1024 nt lds
  v_xor_b32 v50, 128, v2
  buffer_load_dwordx4 v50, s[40:43], s7 offen offset:2048 nt lds
  v_xor_b32 v51, 192, v2
  buffer_load_dwordx4 v51, s[40:43], s7 offen offset:3072 nt lds
  v_mfma_f32_16x16x32_bf16 v[28:31], v[36:39], v[12:15], v[28:31]
  v_mfma_f32_16x16x32_bf16 v[28:31], v[40:43], v[16:19], v[28:31]
  v_mfma_f32_16x16x32_bf16 v[28:31], v[44:47], v[20:23], v[28:31]
  s_mov_b64 exec, s[52:53]
  ds_write_b128 v6, v[24:27] offset:1536
  s_mov_b64 exec, -1
  s_waitcnt vmcnt(4)
  ds_read_b128 v[32:35], v52 offset:13312
  ds_read_b128 v[36:39], v53 offset:13312
  ds_read_b128 v[40:43], v54 offset:13312
  ds_read_b128 v[44:47], v55 offset:13312
  s_waitcnt lgkmcnt(0)
  v_mfma_f32_16x16x32_bf16 v[24:27], v[32:35], v[8:11], 0
  s_add_u32 s7, s6, 458752
  s_add_u32 m0, s49, 21504
  s_nop 0
  buffer_load_dwordx4 v2, s[40:43], s7 offen offset:0 nt lds
  v_xor_b32 v51, 64, v2
  buffer_load_dwordx4 v51, s[40:43], s7 offen offset:1024 nt lds
  v_xor_b32 v50, 128, v2
  buffer_load_dwordx4 v50, s[40:43], s7 offen offset:2048 nt lds
  v_xor_b32 v51, 192, v2
  buffer_load_dwordx4 v51, s[40:43], s7 offen offset:3072 nt lds
  v_mfma_f32_16x16x32_bf16 v[24:27], v[36:39], v[12:15], v[24:27]
  v_mfma_f32_16x16x32_bf16 v[24:27], v[40:43], v[16:19], v[24:27]
  v_mfma_f32_16x16x32_bf16 v[24:27], v[44:47], v[20:23], v[24:27]
  s_mov_b64 exec, s[52:53]
  ds_write_b128 v6, v[28:31] offset:1600
  s_mov_b64 exec, -1
  s_waitcnt vmcnt(4)
  ds_read_b128 v[32:35], v52 offset:17408
  ds_read_b128 v[36:39], v53 offset:17408
  ds_read_b128 v[40:43], v54 offset:17408
  ds_read_b128 v[44:47], v55 offset:17408
  s_waitcnt lgkmcnt(0)
  v_mfma_f32_16x16x32_bf16 v[28:31], v[32:35], v[8:11], 0
  s_add_u32 s7, s6, 475136
  s_add_u32 m0, s49, 25600
  s_nop 0
  buffer_load_dwordx4 v2, s[40:43], s7 offen offset:0 nt lds
  v_xor_b32 v51, 64, v2
  buffer_load_dwordx4 v51, s[40:43], s7 offen offset:1024 nt lds
  v_xor_b32 v50, 128, v2
  buffer_load_dwordx4 v50, s[40:43], s7 offen offset:2048 nt lds
  v_xor_b32 v51, 192, v2
  buffer_load_dwordx4 v51, s[40:43], s7 offen offset:3072 nt lds
  v_mfma_f32_16x16x32_bf16 v[28:31], v[36:39], v[12:15], v[28:31]
  v_mfma_f32_16x16x32_bf16 v[28:31], v[40:43], v[16:19], v[28:31]
  v_mfma_f32_16x16x32_bf16 v[28:31], v[44:47], v[20:23], v[28:31]
  s_mov_b64 exec, s[52:53]
  ds_write_b128 v6, v[24:27] offset:1664
  s_mov_b64 exec, -1
  s_waitcnt vmcnt(4)
  ds_read_b128 v[32:35], v52 offset:21504
  ds_read_b128 v[36:39], v53 offset:21504
  ds_read_b128 v[40:43], v54 offset:21504
  ds_read_b128 v[44:47], v55 offset:21504
  s_waitcnt lgkmcnt(0)
  v_mfma_f32_16x16x32_bf16 v[24:27], v[32:35], v[8:11], 0
  s_add_u32 s7, s6, 491520
  s_add_u32 m0, s49, 29696
  s_nop 0
  buffer_load_dwordx4 v2, s[40:43], s7 offen offset:0 nt lds
  v_xor_b32 v51, 64, v2
  buffer_load_dwordx4 v51, s[40:43], s7 offen offset:1024 nt lds
  v_xor_b32 v50, 128, v2
  buffer_load_dwordx4 v50, s[40:43], s7 offen offset:2048 nt lds
  v_xor_b32 v51, 192, v2
  buffer_load_dwordx4 v51, s[40:43], s7 offen offset:3072 nt lds
  v_mfma_f32_16x16x32_bf16 v[24:27], v[36:39], v[12:15], v[24:27]
  v_mfma_f32_16x16x32_bf16 v[24:27], v[40:43], v[16:19], v[24:27]
  v_mfma_f32_16x16x32_bf16 v[24:27], v[44:47], v[20:23], v[24:27]
  s_mov_b64 exec, s[52:53]
  ds_write_b128 v6, v[28:31] offset:1728
  s_mov_b64 exec, -1
  s_waitcnt vmcnt(4)
  ds_read_b128 v[32:35], v52 offset:25600
  ds_read_b128 v[36:39], v53 offset:25600
  ds_read_b128 v[40:43], v54 offset:25600
  ds_read_b128 v[44:47], v55 offset:25600
  s_waitcnt lgkmcnt(0)
  v_mfma_f32_16x16x32_bf16 v[28:31], v[32:35], v[8:11], 0
  s_add_u32 s7, s6, 507904
  s_add_u32 m0, s49, 33792
  s_nop 0
  buffer_load_dwordx4 v2, s[40:43], s7 offen offset:0 nt lds
  v_xor_b32 v51, 64, v2
  buffer_load_dwordx4 v51, s[40:43], s7 offen offset:1024 nt lds
  v_xor_b32 v50, 128, v2
  buffer_load_dwordx4 v50, s[40:43], s7 offen offset:2048 nt lds
  v_xor_b32 v51, 192, v2
  buffer_load_dwordx4 v51, s[40:43], s7 offen offset:3072 nt lds
  v_mfma_f32_16x16x32_bf16 v[28:31], v[36:39], v[12:15], v[28:31]
  v_mfma_f32_16x16x32_bf16 v[28:31], v[40:43], v[16:19], v[28:31]
  v_mfma_f32_16x16x32_bf16 v[28:31], v[44:47], v[20:23], v[28:31]
  s_mov_b64 exec, s[52:53]
  ds_write_b128 v6, v[24:27] offset:1792
  s_mov_b64 exec, -1
  s_waitcnt vmcnt(4)
  s_mov_b64 exec, 1
  v_mov_b32 v4, s74
  v_mov_b32 v5, 30
  global_store_dword v4, v5, s[26:27] sc1
  s_mov_b64 exec, -1
  ds_read_b128 v[32:35], v52 offset:29696
  ds_read_b128 v[36:39], v53 offset:29696
  ds_read_b128 v[40:43], v54 offset:29696
  ds_read_b128 v[44:47], v55 offset:29696
  s_waitcnt lgkmcnt(0)
  v_mfma_f32_16x16x32_bf16 v[24:27], v[32:35], v[8:11], 0
  s_add_u32 s7, s6, 0
  buffer_load_dwordx4 v[168:171], v1, s[44:47], s7 offen offset:0 nt
  buffer_load_dwordx4 v[172:175], v1, s[44:47], s7 offen offset:256 nt
  buffer_load_dwordx4 v[176:179], v1, s[44:47], s7 offen offset:512 nt
  v_mfma_f32_16x16x32_bf16 v[24:27], v[36:39], v[12:15], v[24:27]
  v_mfma_f32_16x16x32_bf16 v[24:27], v[40:43], v[16:19], v[24:27]
  v_mfma_f32_16x16x32_bf16 v[24:27], v[44:47], v[20:23], v[24:27]
  s_mov_b64 exec, s[52:53]
  ds_write_b128 v6, v[28:31] offset:1856
  s_mov_b64 exec, -1
  s_waitcnt vmcnt(4)
  s_mov_b64 exec, 1
  v_mov_b32 v4, s74
  v_mov_b32 v5, 31
  global_store_dword v4, v5, s[26:27] sc1
  s_mov_b64 exec, -1
  ds_read_b128 v[32:35], v52 offset:33792
  ds_read_b128 v[36:39], v53 offset:33792
  ds_read_b128 v[40:43], v54 offset:33792
  ds_read_b128 v[44:47], v55 offset:33792
  s_waitcnt lgkmcnt(0)
  v_mfma_f32_16x16x32_bf16 v[28:31], v[32:35], v[8:11], 0
  buffer_load_dwordx4 v[180:183], v1, s[44:47], s7 offen offset:768 nt
  s_add_u32 s7, s6, 16384
  buffer_load_dwordx4 v[184:187], v1, s[44:47], s7 offen offset:0 nt
  buffer_load_dwordx4 v[188:191], v1, s[44:47], s7 offen offset:256 nt
  v_mfma_f32_16x16x32_bf16 v[28:31], v[36:39], v[12:15], v[28:31]
  v_mfma_f32_16x16x32_bf16 v[28:31], v[40:43], v[16:19], v[28:31]
  v_mfma_f32_16x16x32_bf16 v[28:31], v[44:47], v[20:23], v[28:31]
  s_mov_b64 exec, s[52:53]
  ds_write_b128 v6, v[24:27] offset:1920
  s_mov_b64 exec, -1
  s_mov_b64 exec, s[52:53]
  s_nop 3
  ds_write_b128 v6, v[28:31] offset:1984
  s_mov_b64 exec, -1
  v_lshlrev_b32 v4, 5, v0
  s_lshl_b32 s12, s3, 11
  v_add_u32 v4, s12, v4
  s_waitcnt lgkmcnt(0)
  ds_read_b128 v[40:43], v4
  ds_read_b128 v[44:47], v4 offset:16
  s_waitcnt lgkmcnt(0)
  v_cvt_pk_bf16_f32 v32, v40, v41
  v_cvt_pk_bf16_f32 v33, v42, v43
  v_cvt_pk_bf16_f32 v34, v44, v45
  v_cvt_pk_bf16_f32 v35, v46, v47
  v_lshlrev_b32 v40, 16, v32
  v_and_b32 v41, 0xffff0000, v32
  v_lshlrev_b32 v42, 16, v33
  v_and_b32 v43, 0xffff0000, v33
  v_lshlrev_b32 v44, 16, v34
  v_and_b32 v45, 0xffff0000, v34
  v_lshlrev_b32 v46, 16, v35
  v_and_b32 v47, 0xffff0000, v35
  v_mul_f32 v40, s9, v40
  v_mul_f32 v41, s9, v41
  v_mul_f32 v42, s9, v42
  v_mul_f32 v43, s9, v43
  v_mul_f32 v44, s9, v44
  v_mul_f32 v45, s9, v45
  v_mul_f32 v46, s9, v46
  v_mul_f32 v47, s9, v47
  v_cvt_pk_bf16_f32 v32, v40, v41
  v_cvt_pk_bf16_f32 v33, v42, v43
  v_cvt_pk_bf16_f32 v34, v44, v45
  v_cvt_pk_bf16_f32 v35, v46, v47
  v_lshlrev_b32 v40, 16, v32
  v_and_b32 v41, 0xffff0000, v32
  v_lshlrev_b32 v42, 16, v33
  v_and_b32 v43, 0xffff0000, v33
  v_lshlrev_b32 v44, 16, v34
  v_and_b32 v45, 0xffff0000, v34
  v_lshlrev_b32 v46, 16, v35
  v_and_b32 v47, 0xffff0000, v35
  v_max3_f32 v48, v40, v41, v42
  v_max3_f32 v48, v48, v43, v44
  v_max3_f32 v48, v48, v45, v46
  v_max_f32 v48, v48, v47
  s_nop 1
  v_max_f32_dpp v48, v48, v48 quad_perm:[1,0,3,2] row_mask:0xf bank_mask:0xf
  s_nop 1
  v_max_f32_dpp v48, v48, v48 quad_perm:[2,3,0,1] row_mask:0xf bank_mask:0xf
  s_nop 1
  v_max_f32_dpp v48, v48, v48 row_half_mirror row_mask:0xf bank_mask:0xf
  s_nop 1
  v_max_f32_dpp v48, v48, v48 row_mirror row_mask:0xf bank_mask:0xf
  v_mov_b32 v5, v48
  s_nop 1
  v_permlane16_swap_b32 v5, v48
  v_max_f32 v48, v48, v5
  v_mov_b32 v5, v48
  s_nop 1
  v_permlane32_swap_b32 v5, v48
  v_max_f32 v48, v48, v5
  v_mul_f32 v5, s8, v48
  v_fma_f32 v40, v40, s8, -v5
  v_fma_f32 v41, v41, s8, -v5
  v_fma_f32 v42, v42, s8, -v5
  v_fma_f32 v43, v43, s8, -v5
  v_fma_f32 v44, v44, s8, -v5
  v_fma_f32 v45, v45, s8, -v5
  v_fma_f32 v46, v46, s8, -v5
  v_fma_f32 v47, v47, s8, -v5
  v_exp_f32 v40, v40
  v_exp_f32 v41, v41
  v_exp_f32 v42, v42
  v_exp_f32 v43, v43
  v_exp_f32 v44, v44
  v_exp_f32 v45, v45
  v_exp_f32 v46, v46
  v_exp_f32 v47, v47
  v_add_f32 v49, v40, v41
  v_add_f32 v49, v49, v42
  v_add_f32 v49, v49, v43
  v_add_f32 v49, v49, v44
  v_add_f32 v49, v49, v45
  v_add_f32 v49, v49, v46
  v_add_f32 v49, v49, v47
  v_cvt_pk_bf16_f32 v32, v40, v41
  v_cvt_pk_bf16_f32 v33, v42, v43
  v_cvt_pk_bf16_f32 v34, v44, v45
  v_cvt_pk_bf16_f32 v35, v46, v47
  v_lshlrev_b32 v40, 16, v32
  v_and_b32 v41, 0xffff0000, v32
  v_lshlrev_b32 v42, 16, v33
  v_and_b32 v43, 0xffff0000, v33
  v_lshlrev_b32 v44, 16, v34
  v_and_b32 v45, 0xffff0000, v34
  v_lshlrev_b32 v46, 16, v35
  v_and_b32 v47, 0xffff0000, v35
  ds_write_b128 v4, v[40:43]
  ds_write_b128 v4, v[44:47] offset:16
  v_add_f32_dpp v49, v49, v49 quad_perm:[1,0,3,2] row_mask:0xf bank_mask:0xf
  s_nop 1
  v_add_f32_dpp v49, v49, v49 quad_perm:[2,3,0,1] row_mask:0xf bank_mask:0xf
  s_nop 1
  v_add_f32_dpp v49, v49, v49 row_half_mirror row_mask:0xf bank_mask:0xf
  s_nop 1
  v_add_f32_dpp v49, v49, v49 row_mirror row_mask:0xf bank_mask:0xf
  v_mov_b32 v5, v49
  s_nop 1
  v_permlane16_swap_b32 v5, v49
  v_add_f32 v49, v49, v5
  v_mov_b32 v5, v49
  s_nop 1
  v_permlane32_swap_b32 v5, v49
  v_add_f32 v49, v49, v5
  v_mov_b32 v40, 0
  v_mov_b32 v41, 0
  v_mov_b32 v42, 0
  v_mov_b32 v43, 0
  v_mov_b32 v44, 0
  v_mov_b32 v45, 0
  v_mov_b32 v46, 0
  v_mov_b32 v47, 0
  s_waitcnt lgkmcnt(0)
  v_lshrrev_b32 v4, 3, v0
  v_lshlrev_b32 v4, 10, v4
  v_and_b32 v5, 7, v0
  v_lshl_add_u32 v4, v5, 4, v4
  s_lshl_b32 s12, s4, 17
  s_lshl_b32 s13, s5, 7
  s_add_u32 s12, s12, s13
  s_lshl_b32 s13, s3, 15
  s_add_u32 s12, s12, s13
  v_add_u32 v4, s12, v4
  global_load_dwordx4 v[8:11], v4, s[24:25]
  v_add_u32 v4, 0x2000, v4
  global_load_dwordx4 v[12:15], v4, s[24:25]
  v_add_u32 v4, 0x2000, v4
  global_load_dwordx4 v[16:19], v4, s[24:25]
  v_add_u32 v4, 0x2000, v4
  global_load_dwordx4 v[20:23], v4, s[24:25]
  ds_read_b128 v[32:35], v6 offset:0
  s_waitcnt lgkmcnt(0)
  ds_read_b128 v[36:39], v6 offset:64
  s_waitcnt vmcnt(10)
  v_lshrrev_b32 v50, 16, v32
  v_dot2c_f32_bf16 v40, v168, v50
  v_dot2c_f32_bf16 v41, v168, v32
  v_dot2c_f32_bf16 v42, v169, v50
  v_dot2c_f32_bf16 v43, v169, v32
  v_dot2c_f32_bf16 v44, v170, v50
  v_dot2c_f32_bf16 v45, v170, v32
  v_dot2c_f32_bf16 v46, v171, v50
  v_dot2c_f32_bf16 v47, v171, v32
  s_waitcnt vmcnt(9)
  v_lshrrev_b32 v51, 16, v33
  v_dot2c_f32_bf16 v40, v172, v51
  v_dot2c_f32_bf16 v41, v172, v33
  v_dot2c_f32_bf16 v42, v173, v51
  v_dot2c_f32_bf16 v43, v173, v33
  v_dot2c_f32_bf16 v44, v174, v51
  v_dot2c_f32_bf16 v45, v174, v33
  v_dot2c_f32_bf16 v46, v175, v51
  v_dot2c_f32_bf16 v47, v175, v33
  s_waitcnt vmcnt(8)
  v_lshrrev_b32 v50, 16, v34
  v_dot2c_f32_bf16 v40, v176, v50
  v_dot2c_f32_bf16 v41, v176, v34
  v_dot2c_f32_bf16 v42, v177, v50
  v_dot2c_f32_bf16 v43, v177, v34
  v_dot2c_f32_bf16 v44, v178, v50
  v_dot2c_f32_bf16 v45, v178, v34
  v_dot2c_f32_bf16 v46, v179, v50
  v_dot2c_f32_bf16 v47, v179, v34
  s_waitcnt vmcnt(6)
  v_and_b32 v4, 7, v0
  v_lshlrev_b32 v4, 9, v4
  v_xor_b32 v4, s74, v4
  global_load_dword v54, v4, s[26:27] sc1
  v_lshrrev_b32 v51, 16, v35
  v_dot2c_f32_bf16 v40, v180, v51
  v_dot2c_f32_bf16 v41, v180, v35
  v_dot2c_f32_bf16 v42, v181, v51
  v_dot2c_f32_bf16 v43, v181, v35
  v_dot2c_f32_bf16 v44, v182, v51
  v_dot2c_f32_bf16 v45, v182, v35
  v_dot2c_f32_bf16 v46, v183, v51
  v_dot2c_f32_bf16 v47, v183, v35
  buffer_load_dwordx4 v[192:195], v1, s[44:47], s7 offen offset:512 nt
  s_waitcnt lgkmcnt(0)
  ds_read_b128 v[32:35], v6 offset:128
  s_waitcnt vmcnt(7)
  v_lshrrev_b32 v50, 16, v36
  v_dot2c_f32_bf16 v40, v184, v50
  v_dot2c_f32_bf16 v41, v184, v36
  v_dot2c_f32_bf16 v42, v185, v50
  v_dot2c_f32_bf16 v43, v185, v36
  v_dot2c_f32_bf16 v44, v186, v50
  v_dot2c_f32_bf16 v45, v186, v36
  v_dot2c_f32_bf16 v46, v187, v50
  v_dot2c_f32_bf16 v47, v187, v36
  buffer_load_dwordx4 v[196:199], v1, s[44:47], s7 offen offset:768 nt
  s_waitcnt vmcnt(7)
  v_lshrrev_b32 v51, 16, v37
  v_dot2c_f32_bf16 v40, v188, v51
  v_dot2c_f32_bf16 v41, v188, v37
  v_dot2c_f32_bf16 v42, v189, v51
  v_dot2c_f32_bf16 v43, v189, v37
  v_dot2c_f32_bf16 v44, v190, v51
  v_dot2c_f32_bf16 v45, v190, v37
  v_dot2c_f32_bf16 v46, v191, v51
  v_dot2c_f32_bf16 v47, v191, v37
  s_add_u32 s7, s6, 32768
  buffer_load_dwordx4 v[200:203], v1, s[44:47], s7 offen offset:0 nt
  s_waitcnt vmcnt(2)
  v_lshrrev_b32 v50, 16, v38
  v_dot2c_f32_bf16 v40, v192, v50
  v_dot2c_f32_bf16 v41, v192, v38
  v_dot2c_f32_bf16 v42, v193, v50
  v_dot2c_f32_bf16 v43, v193, v38
  v_dot2c_f32_bf16 v44, v194, v50
  v_dot2c_f32_bf16 v45, v194, v38
  v_dot2c_f32_bf16 v46, v195, v50
  v_dot2c_f32_bf16 v47, v195, v38
  buffer_load_dwordx4 v[204:207], v1, s[44:47], s7 offen offset:256 nt
  buffer_load_dwordx4 v[208:211], v1, s[44:47], s7 offen offset:512 nt
  buffer_load_dwordx4 v[212:215], v1, s[44:47], s7 offen offset:768 nt
  s_add_u32 s7, s6, 49152
  buffer_load_dwordx4 v[216:219], v1, s[44:47], s7 offen offset:0 nt
  buffer_load_dwordx4 v[220:223], v1, s[44:47], s7 offen offset:256 nt
  buffer_load_dwordx4 v[224:227], v1, s[44:47], s7 offen offset:512 nt
  s_waitcnt vmcnt(7)
  v_lshrrev_b32 v51, 16, v39
  v_dot2c_f32_bf16 v40, v196, v51
  v_dot2c_f32_bf16 v41, v196, v39
  v_dot2c_f32_bf16 v42, v197, v51
  v_dot2c_f32_bf16 v43, v197, v39
  v_dot2c_f32_bf16 v44, v198, v51
  v_dot2c_f32_bf16 v45, v198, v39
  v_dot2c_f32_bf16 v46, v199, v51
  v_dot2c_f32_bf16 v47, v199, v39
  buffer_load_dwordx4 v[228:231], v1, s[44:47], s7 offen offset:768 nt
  s_waitcnt lgkmcnt(0)
  ds_read_b128 v[36:39], v6 offset:192
  s_waitcnt vmcnt(7)
  v_lshrrev_b32 v50, 16, v32
  v_dot2c_f32_bf16 v40, v200, v50
  v_dot2c_f32_bf16 v41, v200, v32
  v_dot2c_f32_bf16 v42, v201, v50
  v_dot2c_f32_bf16 v43, v201, v32
  v_dot2c_f32_bf16 v44, v202, v50
  v_dot2c_f32_bf16 v45, v202, v32
  v_dot2c_f32_bf16 v46, v203, v50
  v_dot2c_f32_bf16 v47, v203, v32
  s_add_u32 s7, s6, 65536
  buffer_load_dwordx4 v[168:171], v1, s[44:47], s7 offen offset:0 nt
  s_waitcnt vmcnt(7)
  v_lshrrev_b32 v51, 16, v33
  v_dot2c_f32_bf16 v40, v204, v51
  v_dot2c_f32_bf16 v41, v204, v33
  v_dot2c_f32_bf16 v42, v205, v51
  v_dot2c_f32_bf16 v43, v205, v33
  v_dot2c_f32_bf16 v44, v206, v51
  v_dot2c_f32_bf16 v45, v206, v33
  v_dot2c_f32_bf16 v46, v207, v51
  v_dot2c_f32_bf16 v47, v207, v33
  buffer_load_dwordx4 v[172:175], v1, s[44:47], s7 offen offset:256 nt
  s_waitcnt vmcnt(7)
  v_lshrrev_b32 v50, 16, v34
  v_dot2c_f32_bf16 v40, v208, v50
  v_dot2c_f32_bf16 v41, v208, v34
  v_dot2c_f32_bf16 v42, v209, v50
  v_dot2c_f32_bf16 v43, v209, v34
  v_dot2c_f32_bf16 v44, v210, v50
  v_dot2c_f32_bf16 v45, v210, v34
  v_dot2c_f32_bf16 v46, v211, v50
  v_dot2c_f32_bf16 v47, v211, v34
  buffer_load_dwordx4 v[176:179], v1, s[44:47], s7 offen offset:512 nt
  s_waitcnt vmcnt(7)
  v_cmp_gt_u32 vcc, 30, v54
  s_cbranch_vccz L_pok_5
  v_and_b32 v4, 7, v0
  v_lshlrev_b32 v4, 9, v4
  v_xor_b32 v4, s74, v4
L_psp_4:
  global_load_dword v5, v4, s[26:27] sc1
  s_waitcnt vmcnt(0)
  v_cmp_gt_u32 vcc, 31, v5
  s_sub_u32 s11, s11, 1
  s_cbranch_scc1 L_pok_5
  s_cbranch_vccnz L_psp_4
L_pok_5:
  v_lshrrev_b32 v51, 16, v35
  v_dot2c_f32_bf16 v40, v212, v51
  v_dot2c_f32_bf16 v41, v212, v35
  v_dot2c_f32_bf16 v42, v213, v51
  v_dot2c_f32_bf16 v43, v213, v35
  v_dot2c_f32_bf16 v44, v214, v51
  v_dot2c_f32_bf16 v45, v214, v35
  v_dot2c_f32_bf16 v46, v215, v51
  v_dot2c_f32_bf16 v47, v215, v35
  buffer_load_dwordx4 v[180:183], v1, s[44:47], s7 offen offset:768 nt
  s_waitcnt lgkmcnt(0)
  ds_read_b128 v[32:35], v6 offset:256
  s_waitcnt vmcnt(7)
  v_lshrrev_b32 v50, 16, v36
  v_dot2c_f32_bf16 v40, v216, v50
  v_dot2c_f32_bf16 v41, v216, v36
  v_dot2c_f32_bf16 v42, v217, v50
  v_dot2c_f32_bf16 v43, v217, v36
  v_dot2c_f32_bf16 v44, v218, v50
  v_dot2c_f32_bf16 v45, v218, v36
  v_dot2c_f32_bf16 v46, v219, v50
  v_dot2c_f32_bf16 v47, v219, v36
  s_add_u32 s7, s6, 81920
  buffer_load_dwordx4 v[184:187], v1, s[44:47], s7 offen offset:0 nt
  s_waitcnt vmcnt(7)
  v_lshrrev_b32 v51, 16, v37
  v_dot2c_f32_bf16 v40, v220, v51
  v_dot2c_f32_bf16 v41, v220, v37
  v_dot2c_f32_bf16 v42, v221, v51
  v_dot2c_f32_bf16 v43, v221, v37
  v_dot2c_f32_bf16 v44, v222, v51
  v_dot2c_f32_bf16 v45, v222, v37
  v_dot2c_f32_bf16 v46, v223, v51
  v_dot2c_f32_bf16 v47, v223, v37
  buffer_load_dwordx4 v[188:191], v1, s[44:47], s7 offen offset:256 nt
  s_waitcnt vmcnt(7)
  v_lshrrev_b32 v50, 16, v38
  v_dot2c_f32_bf16 v40, v224, v50
  v_dot2c_f32_bf16 v41, v224, v38
  v_dot2c_f32_bf16 v42, v225, v50
  v_dot2c_f32_bf16 v43, v225, v38
  v_dot2c_f32_bf16 v44, v226, v50
  v_dot2c_f32_bf16 v45, v226, v38
  v_dot2c_f32_bf16 v46, v227, v50
  v_dot2c_f32_bf16 v47, v227, v38
  buffer_load_dwordx4 v[192:195], v1, s[44:47], s7 offen offset:512 nt
  s_waitcnt vmcnt(7)
  v_lshrrev_b32 v51, 16, v39
  v_dot2c_f32_bf16 v40, v228, v51
  v_dot2c_f32_bf16 v41, v228, v39
  v_dot2c_f32_bf16 v42, v229, v51
  v_dot2c_f32_bf16 v43, v229, v39
  v_dot2c_f32_bf16 v44, v230, v51
  v_dot2c_f32_bf16 v45, v230, v39
  v_dot2c_f32_bf16 v46, v231, v51
  v_dot2c_f32_bf16 v47, v231, v39
  buffer_load_dwordx4 v[196:199], v1, s[44:47], s7 offen offset:768 nt
  s_waitcnt lgkmcnt(0)
  ds_read_b128 v[36:39], v6 offset:320
  s_waitcnt vmcnt(7)
  v_lshrrev_b32 v50, 16, v32
  v_dot2c_f32_bf16 v40, v168, v50
  v_dot2c_f32_bf16 v41, v168, v32
  v_dot2c_f32_bf16 v42, v169, v50
  v_dot2c_f32_bf16 v43, v169, v32
  v_dot2c_f32_bf16 v44, v170, v50
  v_dot2c_f32_bf16 v45, v170, v32
  v_dot2c_f32_bf16 v46, v171, v50
  v_dot2c_f32_bf16 v47, v171, v32
  s_add_u32 s7, s6, 98304
  buffer_load_dwordx4 v[200:203], v1, s[44:47], s7 offen offset:0 nt
  s_waitcnt vmcnt(7)
  v_lshrrev_b32 v51, 16, v33
  v_dot2c_f32_bf16 v40, v172, v51
  v_dot2c_f32_bf16 v41, v172, v33
  v_dot2c_f32_bf16 v42, v173, v51
  v_dot2c_f32_bf16 v43, v173, v33
  v_dot2c_f32_bf16 v44, v174, v51
  v_dot2c_f32_bf16 v45, v174, v33
  v_dot2c_f32_bf16 v46, v175, v51
  v_dot2c_f32_bf16 v47, v175, v33
  buffer_load_dwordx4 v[204:207], v1, s[44:47], s7 offen offset:256 nt
  s_waitcnt vmcnt(7)
  v_lshrrev_b32 v50, 16, v34
  v_dot2c_f32_bf16 v40, v176, v50
  v_dot2c_f32_bf16 v41, v176, v34
  v_dot2c_f32_bf16 v42, v177, v50
  v_dot2c_f32_bf16 v43, v177, v34
  v_dot2c_f32_bf16 v44, v178, v50
  v_dot2c_f32_bf16 v45, v178, v34
  v_dot2c_f32_bf16 v46, v179, v50
  v_dot2c_f32_bf16 v47, v179, v34
  buffer_load_dwordx4 v[208:211], v1, s[44:47], s7 offen offset:512 nt
  s_waitcnt vmcnt(7)
  v_lshrrev_b32 v51, 16, v35
  v_dot2c_f32_bf16 v40, v180, v51
  v_dot2c_f32_bf16 v41, v180, v35
  v_dot2c_f32_bf16 v42, v181, v51
  v_dot2c_f32_bf16 v43, v181, v35
  v_dot2c_f32_bf16 v44, v182, v51
  v_dot2c_f32_bf16 v45, v182, v35
  v_dot2c_f32_bf16 v46, v183, v51
  v_dot2c_f32_bf16 v47, v183, v35
  buffer_load_dwordx4 v[212:215], v1, s[44:47], s7 offen offset:768 nt
  s_waitcnt lgkmcnt(0)
  ds_read_b128 v[32:35], v6 offset:384
  s_waitcnt vmcnt(7)
  v_lshrrev_b32 v50, 16, v36
  v_dot2c_f32_bf16 v40, v184, v50
  v_dot2c_f32_bf16 v41, v184, v36
  v_dot2c_f32_bf16 v42, v185, v50
  v_dot2c_f32_bf16 v43, v185, v36
  v_dot2c_f32_bf16 v44, v186, v50
  v_dot2c_f32_bf16 v45, v186, v36
  v_dot2c_f32_bf16 v46, v187, v50
  v_dot2c_f32_bf16 v47, v187, v36
  s_add_u32 s7, s6, 114688
  buffer_load_dwordx4 v[216:219], v1, s[44:47], s7 offen offset:0 nt
  s_waitcnt vmcnt(7)
  v_lshrrev_b32 v51, 16, v37
  v_dot2c_f32_bf16 v40, v188, v51
  v_dot2c_f32_bf16 v41, v188, v37
  v_dot2c_f32_bf16 v42, v189, v51
  v_dot2c_f32_bf16 v43, v189, v37
  v_dot2c_f32_bf16 v44, v190, v51
  v_dot2c_f32_bf16 v45, v190, v37
  v_dot2c_f32_bf16 v46, v191, v51
  v_dot2c_f32_bf16 v47, v191, v37
  buffer_load_dwordx4 v[220:223], v1, s[44:47], s7 offen offset:256 nt
  s_waitcnt vmcnt(7)
  v_lshrrev_b32 v50, 16, v38
  v_dot2c_f32_bf16 v40, v192, v50
  v_dot2c_f32_bf16 v41, v192, v38
  v_dot2c_f32_bf16 v42, v193, v50
  v_dot2c_f32_bf16 v43, v193, v38
  v_dot2c_f32_bf16 v44, v194, v50
  v_dot2c_f32_bf16 v45, v194, v38
  v_dot2c_f32_bf16 v46, v195, v50
  v_dot2c_f32_bf16 v47, v195, v38
  buffer_load_dwordx4 v[224:227], v1, s[44:47], s7 offen offset:512 nt
  s_waitcnt vmcnt(7)
  v_lshrrev_b32 v51, 16, v39
  v_dot2c_f32_bf16 v40, v196, v51
  v_dot2c_f32_bf16 v41, v196, v39
  v_dot2c_f32_bf16 v42, v197, v51
  v_dot2c_f32_bf16 v43, v197, v39
  v_dot2c_f32_bf16 v44, v198, v51
  v_dot2c_f32_bf16 v45, v198, v39
  v_dot2c_f32_bf16 v46, v199, v51
  v_dot2c_f32_bf16 v47, v199, v39
  buffer_load_dwordx4 v[228:231], v1, s[44:47], s7 offen offset:768 nt
  s_waitcnt lgkmcnt(0)
  ds_read_b128 v[36:39], v6 offset:448
  s_waitcnt vmcnt(7)
  v_lshrrev_b32 v50, 16, v32
  v_dot2c_f32_bf16 v40, v200, v50
  v_dot2c_f32_bf16 v41, v200, v32
  v_dot2c_f32_bf16 v42, v201, v50
  v_dot2c_f32_bf16 v43, v201, v32
  v_dot2c_f32_bf16 v44, v202, v50
  v_dot2c_f32_bf16 v45, v202, v32
  v_dot2c_f32_bf16 v46, v203, v50
  v_dot2c_f32_bf16 v47, v203, v32
  s_add_u32 s7, s6, 131072
  buffer_load_dwordx4 v[168:171], v1, s[44:47], s7 offen offset:0 nt
  s_waitcnt vmcnt(7)
  v_lshrrev_b32 v51, 16, v33
  v_dot2c_f32_bf16 v40, v204, v51
  v_dot2c_f32_bf16 v41, v204, v33
  v_dot2c_f32_bf16 v42, v205, v51
  v_dot2c_f32_bf16 v43, v205, v33
  v_dot2c_f32_bf16 v44, v206, v51
  v_dot2c_f32_bf16 v45, v206, v33
  v_dot2c_f32_bf16 v46, v207, v51
  v_dot2c_f32_bf16 v47, v207, v33
  buffer_load_dwordx4 v[172:175], v1, s[44:47], s7 offen offset:256 nt
  s_waitcnt vmcnt(7)
  v_lshrrev_b32 v50, 16, v34
  v_dot2c_f32_bf16 v40, v208, v50
  v_dot2c_f32_bf16 v41, v208, v34
  v_dot2c_f32_bf16 v42, v209, v50
  v_dot2c_f32_bf16 v43, v209, v34
  v_dot2c_f32_bf16 v44, v210, v50
  v_dot2c_f32_bf16 v45, v210, v34
  v_dot2c_f32_bf16 v46, v211, v50
  v_dot2c_f32_bf16 v47, v211, v34
  buffer_load_dwordx4 v[176:179], v1, s[44:47], s7 offen offset:512 nt
  s_waitcnt vmcnt(7)
  v_lshrrev_b32 v51, 16, v35
  v_dot2c_f32_bf16 v40, v212, v51
  v_dot2c_f32_bf16 v41, v212, v35
  v_dot2c_f32_bf16 v42, v213, v51
  v_dot2c_f32_bf16 v43, v213, v35
  v_dot2c_f32_bf16 v44, v214, v51
  v_dot2c_f32_bf16 v45, v214, v35
  v_dot2c_f32_bf16 v46, v215, v51
  v_dot2c_f32_bf16 v47, v215, v35
  buffer_load_dwordx4 v[180:183], v1, s[44:47], s7 offen offset:768 nt
  s_waitcnt lgkmcnt(0)
  ds_read_b128 v[32:35], v6 offset:512
  s_waitcnt vmcnt(7)
  v_lshrrev_b32 v50, 16, v36
  v_dot2c_f32_bf16 v40, v216, v50
  v_dot2c_f32_bf16 v41, v216, v36
  v_dot2c_f32_bf16 v42, v217, v50
  v_dot2c_f32_bf16 v43, v217, v36
  v_dot2c_f32_bf16 v44, v218, v50
  v_dot2c_f32_bf16 v45, v218, v36
  v_dot2c_f32_bf16 v46, v219, v50
  v_dot2c_f32_bf16 v47, v219, v36
  s_add_u32 s7, s6, 147456
  buffer_load_dwordx4 v[184:187], v1, s[44:47], s7 offen offset:0 nt
  s_waitcnt vmcnt(7)
  v_lshrrev_b32 v51, 16, v37
  v_dot2c_f32_bf16 v40, v220, v51
  v_dot2c_f32_bf16 v41, v220, v37
  v_dot2c_f32_bf16 v42, v221, v51
  v_dot2c_f32_bf16 v43, v221, v37
  v_dot2c_f32_bf16 v44, v222, v51
  v_dot2c_f32_bf16 v45, v222, v37
  v_dot2c_f32_bf16 v46, v223, v51
  v_dot2c_f32_bf16 v47, v223, v37
  buffer_load_dwordx4 v[188:191], v1, s[44:47], s7 offen offset:256 nt
  s_waitcnt vmcnt(7)
  v_lshrrev_b32 v50, 16, v38
  v_dot2c_f32_bf16 v40, v224, v50
  v_dot2c_f32_bf16 v41, v224, v38
  v_dot2c_f32_bf16 v42, v225, v50
  v_dot2c_f32_bf16 v43, v225, v38
  v_dot2c_f32_bf16 v44, v226, v50
  v_dot2c_f32_bf16 v45, v226, v38
  v_dot2c_f32_bf16 v46, v227, v50
  v_dot2c_f32_bf16 v47, v227, v38
  buffer_load_dwordx4 v[192:195], v1, s[44:47], s7 offen offset:512 nt
  s_waitcnt vmcnt(7)
  v_lshrrev_b32 v51, 16, v39
  v_dot2c_f32_bf16 v40, v228, v51
  v_dot2c_f32_bf16 v41, v228, v39
  v_dot2c_f32_bf16 v42, v229, v51
  v_dot2c_f32_bf16 v43, v229, v39
  v_dot2c_f32_bf16 v44, v230, v51
  v_dot2c_f32_bf16 v45, v230, v39
  v_dot2c_f32_bf16 v46, v231, v51
  v_dot2c_f32_bf16 v47, v231, v39
  buffer_load_dwordx4 v[196:199], v1, s[44:47], s7 offen offset:768 nt
  s_waitcnt lgkmcnt(0)
  ds_read_b128 v[36:39], v6 offset:576
  s_waitcnt vmcnt(7)
  v_lshrrev_b32 v50, 16, v32
  v_dot2c_f32_bf16 v40, v168, v50
  v_dot2c_f32_bf16 v41, v168, v32
  v_dot2c_f32_bf16 v42, v169, v50
  v_dot2c_f32_bf16 v43, v169, v32
  v_dot2c_f32_bf16 v44, v170, v50
  v_dot2c_f32_bf16 v45, v170, v32
  v_dot2c_f32_bf16 v46, v171, v50
  v_dot2c_f32_bf16 v47, v171, v32
  s_add_u32 s7, s6, 163840
  buffer_load_dwordx4 v[200:203], v1, s[44:47], s7 offen offset:0 nt
  s_waitcnt vmcnt(7)
  v_lshrrev_b32 v51, 16, v33
  v_dot2c_f32_bf16 v40, v172, v51
  v_dot2c_f32_bf16 v41, v172, v33
  v_dot2c_f32_bf16 v42, v173, v51
  v_dot2c_f32_bf16 v43, v173, v33
  v_dot2c_f32_bf16 v44, v174, v51
  v_dot2c_f32_bf16 v45, v174, v33
  v_dot2c_f32_bf16 v46, v175, v51
  v_dot2c_f32_bf16 v47, v175, v33
  buffer_load_dwordx4 v[204:207], v1, s[44:47], s7 offen offset:256 nt
  s_waitcnt vmcnt(7)
  v_lshrrev_b32 v50, 16, v34
  v_dot2c_f32_bf16 v40, v176, v50
  v_dot2c_f32_bf16 v41, v176, v34
  v_dot2c_f32_bf16 v42, v177, v50
  v_dot2c_f32_bf16 v43, v177, v34
  v_dot2c_f32_bf16 v44, v178, v50
  v_dot2c_f32_bf16 v45, v178, v34
  v_dot2c_f32_bf16 v46, v179, v50
  v_dot2c_f32_bf16 v47, v179, v34
  buffer_load_dwordx4 v[208:211], v1, s[44:47], s7 offen offset:512 nt
  s_waitcnt vmcnt(7)
  v_lshrrev_b32 v51, 16, v35
  v_dot2c_f32_bf16 v40, v180, v51
  v_dot2c_f32_bf16 v41, v180, v35
  v_dot2c_f32_bf16 v42, v181, v51
  v_dot2c_f32_bf16 v43, v181, v35
  v_dot2c_f32_bf16 v44, v182, v51
  v_dot2c_f32_bf16 v45, v182, v35
  v_dot2c_f32_bf16 v46, v183, v51
  v_dot2c_f32_bf16 v47, v183, v35
  buffer_load_dwordx4 v[212:215], v1, s[44:47], s7 offen offset:768 nt
  s_waitcnt lgkmcnt(0)
  ds_read_b128 v[32:35], v6 offset:640
  s_waitcnt vmcnt(7)
  v_lshrrev_b32 v50, 16, v36
  v_dot2c_f32_bf16 v40, v184, v50
  v_dot2c_f32_bf16 v41, v184, v36
  v_dot2c_f32_bf16 v42, v185, v50
  v_dot2c_f32_bf16 v43, v185, v36
  v_dot2c_f32_bf16 v44, v186, v50
  v_dot2c_f32_bf16 v45, v186, v36
  v_dot2c_f32_bf16 v46, v187, v50
  v_dot2c_f32_bf16 v47, v187, v36
  s_add_u32 s7, s6, 180224
  buffer_load_dwordx4 v[216:219], v1, s[44:47], s7 offen offset:0 nt
  s_waitcnt vmcnt(7)
  v_lshrrev_b32 v51, 16, v37
  v_dot2c_f32_bf16 v40, v188, v51
  v_dot2c_f32_bf16 v41, v188, v37
  v_dot2c_f32_bf16 v42, v189, v51
  v_dot2c_f32_bf16 v43, v189, v37
  v_dot2c_f32_bf16 v44, v190, v51
  v_dot2c_f32_bf16 v45, v190, v37
  v_dot2c_f32_bf16 v46, v191, v51
  v_dot2c_f32_bf16 v47, v191, v37
  buffer_load_dwordx4 v[220:223], v1, s[44:47], s7 offen offset:256 nt
  s_waitcnt vmcnt(7)
  v_lshrrev_b32 v50, 16, v38
  v_dot2c_f32_bf16 v40, v192, v50
  v_dot2c_f32_bf16 v41, v192, v38
  v_dot2c_f32_bf16 v42, v193, v50
  v_dot2c_f32_bf16 v43, v193, v38
  v_dot2c_f32_bf16 v44, v194, v50
  v_dot2c_f32_bf16 v45, v194, v38
  v_dot2c_f32_bf16 v46, v195, v50
  v_dot2c_f32_bf16 v47, v195, v38
  buffer_load_dwordx4 v[224:227], v1, s[44:47], s7 offen offset:512 nt
  s_waitcnt vmcnt(7)
  v_lshrrev_b32 v51, 16, v39
  v_dot2c_f32_bf16 v40, v196, v51
  v_dot2c_f32_bf16 v41, v196, v39
  v_dot2c_f32_bf16 v42, v197, v51
  v_dot2c_f32_bf16 v43, v197, v39
  v_dot2c_f32_bf16 v44, v198, v51
  v_dot2c_f32_bf16 v45, v198, v39
  v_dot2c_f32_bf16 v46, v199, v51
  v_dot2c_f32_bf16 v47, v199, v39
  buffer_load_dwordx4 v[228:231], v1, s[44:47], s7 offen offset:768 nt
  s_waitcnt lgkmcnt(0)
  ds_read_b128 v[36:39], v6 offset:704
  s_waitcnt vmcnt(7)
  v_lshrrev_b32 v50, 16, v32
  v_dot2c_f32_bf16 v40, v200, v50
  v_dot2c_f32_bf16 v41, v200, v32
  v_dot2c_f32_bf16 v42, v201, v50
  v_dot2c_f32_bf16 v43, v201, v32
  v_dot2c_f32_bf16 v44, v202, v50
  v_dot2c_f32_bf16 v45, v202, v32
  v_dot2c_f32_bf16 v46, v203, v50
  v_dot2c_f32_bf16 v47, v203, v32
  s_add_u32 s7, s6, 196608
  buffer_load_dwordx4 v[168:171], v1, s[44:47], s7 offen offset:0 nt
  s_waitcnt vmcnt(7)
  v_lshrrev_b32 v51, 16, v33
  v_dot2c_f32_bf16 v40, v204, v51
  v_dot2c_f32_bf16 v41, v204, v33
  v_dot2c_f32_bf16 v42, v205, v51
  v_dot2c_f32_bf16 v43, v205, v33
  v_dot2c_f32_bf16 v44, v206, v51
  v_dot2c_f32_bf16 v45, v206, v33
  v_dot2c_f32_bf16 v46, v207, v51
  v_dot2c_f32_bf16 v47, v207, v33
  buffer_load_dwordx4 v[172:175], v1, s[44:47], s7 offen offset:256 nt
  s_waitcnt vmcnt(7)
  v_lshrrev_b32 v50, 16, v34
  v_dot2c_f32_bf16 v40, v208, v50
  v_dot2c_f32_bf16 v41, v208, v34
  v_dot2c_f32_bf16 v42, v209, v50
  v_dot2c_f32_bf16 v43, v209, v34
  v_dot2c_f32_bf16 v44, v210, v50
  v_dot2c_f32_bf16 v45, v210, v34
  v_dot2c_f32_bf16 v46, v211, v50
  v_dot2c_f32_bf16 v47, v211, v34
  buffer_load_dwordx4 v[176:179], v1, s[44:47], s7 offen offset:512 nt
  s_waitcnt vmcnt(7)
  v_lshrrev_b32 v51, 16, v35
  v_dot2c_f32_bf16 v40, v212, v51
  v_dot2c_f32_bf16 v41, v212, v35
  v_dot2c_f32_bf16 v42, v213, v51
  v_dot2c_f32_bf16 v43, v213, v35
  v_dot2c_f32_bf16 v44, v214, v51
  v_dot2c_f32_bf16 v45, v214, v35
  v_dot2c_f32_bf16 v46, v215, v51
  v_dot2c_f32_bf16 v47, v215, v35
  buffer_load_dwordx4 v[180:183], v1, s[44:47], s7 offen offset:768 nt
  s_waitcnt lgkmcnt(0)
  ds_read_b128 v[32:35], v6 offset:768
  s_waitcnt vmcnt(7)
  v_lshrrev_b32 v50, 16, v36
  v_dot2c_f32_bf16 v40, v216, v50
  v_dot2c_f32_bf16 v41, v216, v36
  v_dot2c_f32_bf16 v42, v217, v50
  v_dot2c_f32_bf16 v43, v217, v36
  v_dot2c_f32_bf16 v44, v218, v50
  v_dot2c_f32_bf16 v45, v218, v36
  v_dot2c_f32_bf16 v46, v219, v50
  v_dot2c_f32_bf16 v47, v219, v36
  s_add_u32 s7, s6, 212992
  buffer_load_dwordx4 v[184:187], v1, s[44:47], s7 offen offset:0 nt
  s_waitcnt vmcnt(7)
  v_lshrrev_b32 v51, 16, v37
  v_dot2c_f32_bf16 v40, v220, v51
  v_dot2c_f32_bf16 v41, v220, v37
  v_dot2c_f32_bf16 v42, v221, v51
  v_dot2c_f32_bf16 v43, v221, v37
  v_dot2c_f32_bf16 v44, v222, v51
  v_dot2c_f32_bf16 v45, v222, v37
  v_dot2c_f32_bf16 v46, v223, v51
  v_dot2c_f32_bf16 v47, v223, v37
  buffer_load_dwordx4 v[188:191], v1, s[44:47], s7 offen offset:256 nt
  s_waitcnt vmcnt(7)
  v_lshrrev_b32 v50, 16, v38
  v_dot2c_f32_bf16 v40, v224, v50
  v_dot2c_f32_bf16 v41, v224, v38
  v_dot2c_f32_bf16 v42, v225, v50
  v_dot2c_f32_bf16 v43, v225, v38
  v_dot2c_f32_bf16 v44, v226, v50
  v_dot2c_f32_bf16 v45, v226, v38
  v_dot2c_f32_bf16 v46, v227, v50
  v_dot2c_f32_bf16 v47, v227, v38
  buffer_load_dwordx4 v[192:195], v1, s[44:47], s7 offen offset:512 nt
  s_waitcnt vmcnt(7)
  v_lshrrev_b32 v51, 16, v39
  v_dot2c_f32_bf16 v40, v228, v51
  v_dot2c_f32_bf16 v41, v228, v39
  v_dot2c_f32_bf16 v42, v229, v51
  v_dot2c_f32_bf16 v43, v229, v39
  v_dot2c_f32_bf16 v44, v230, v51
  v_dot2c_f32_bf16 v45, v230, v39
  v_dot2c_f32_bf16 v46, v231, v51
  v_dot2c_f32_bf16 v47, v231, v39
  buffer_load_dwordx4 v[196:199], v1, s[44:47], s7 offen offset:768 nt
  s_waitcnt lgkmcnt(0)
  ds_read_b128 v[36:39], v6 offset:832
  s_waitcnt vmcnt(7)
  v_lshrrev_b32 v50, 16, v32
  v_dot2c_f32_bf16 v40, v168, v50
  v_dot2c_f32_bf16 v41, v168, v32
  v_dot2c_f32_bf16 v42, v169, v50
  v_dot2c_f32_bf16 v43, v169, v32
  v_dot2c_f32_bf16 v44, v170, v50
  v_dot2c_f32_bf16 v45, v170, v32
  v_dot2c_f32_bf16 v46, v171, v50
  v_dot2c_f32_bf16 v47, v171, v32
  s_add_u32 s7, s6, 229376
  buffer_load_dwordx4 v[200:203], v1, s[44:47], s7 offen offset:0 nt
  s_waitcnt vmcnt(7)
  v_lshrrev_b32 v51, 16, v33
  v_dot2c_f32_bf16 v40, v172, v51
  v_dot2c_f32_bf16 v41, v172, v33
  v_dot2c_f32_bf16 v42, v173, v51
  v_dot2c_f32_bf16 v43, v173, v33
  v_dot2c_f32_bf16 v44, v174, v51
  v_dot2c_f32_bf16 v45, v174, v33
  v_dot2c_f32_bf16 v46, v175, v51
  v_dot2c_f32_bf16 v47, v175, v33
  buffer_load_dwordx4 v[204:207], v1, s[44:47], s7 offen offset:256 nt
  s_waitcnt vmcnt(7)
  v_lshrrev_b32 v50, 16, v34
  v_dot2c_f32_bf16 v40, v176, v50
  v_dot2c_f32_bf16 v41, v176, v34
  v_dot2c_f32_bf16 v42, v177, v50
  v_dot2c_f32_bf16 v43, v177, v34
  v_dot2c_f32_bf16 v44, v178, v50
  v_dot2c_f32_bf16 v45, v178, v34
  v_dot2c_f32_bf16 v46, v179, v50
  v_dot2c_f32_bf16 v47, v179, v34
  buffer_load_dwordx4 v[208:211], v1, s[44:47], s7 offen offset:512 nt
  s_waitcnt vmcnt(7)
  v_lshrrev_b32 v51, 16, v35
  v_dot2c_f32_bf16 v40, v180, v51
  v_dot2c_f32_bf16 v41, v180, v35
  v_dot2c_f32_bf16 v42, v181, v51
  v_dot2c_f32_bf16 v43, v181, v35
  v_dot2c_f32_bf16 v44, v182, v51
  v_dot2c_f32_bf16 v45, v182, v35
  v_dot2c_f32_bf16 v46, v183, v51
  v_dot2c_f32_bf16 v47, v183, v35
  buffer_load_dwordx4 v[212:215], v1, s[44:47], s7 offen offset:768 nt
  s_waitcnt lgkmcnt(0)
  ds_read_b128 v[32:35], v6 offset:896
  s_waitcnt vmcnt(7)
  v_lshrrev_b32 v50, 16, v36
  v_dot2c_f32_bf16 v40, v184, v50
  v_dot2c_f32_bf16 v41, v184, v36
  v_dot2c_f32_bf16 v42, v185, v50
  v_dot2c_f32_bf16 v43, v185, v36
  v_dot2c_f32_bf16 v44, v186, v50
  v_dot2c_f32_bf16 v45, v186, v36
  v_dot2c_f32_bf16 v46, v187, v50
  v_dot2c_f32_bf16 v47, v187, v36
  s_add_u32 s7, s6, 245760
  buffer_load_dwordx4 v[216:219], v1, s[44:47], s7 offen offset:0 nt
  s_waitcnt vmcnt(7)
  v_lshrrev_b32 v51, 16, v37
  v_dot2c_f32_bf16 v40, v188, v51
  v_dot2c_f32_bf16 v41, v188, v37
  v_dot2c_f32_bf16 v42, v189, v51
  v_dot2c_f32_bf16 v43, v189, v37
  v_dot2c_f32_bf16 v44, v190, v51
  v_dot2c_f32_bf16 v45, v190, v37
  v_dot2c_f32_bf16 v46, v191, v51
  v_dot2c_f32_bf16 v47, v191, v37
  buffer_load_dwordx4 v[220:223], v1, s[44:47], s7 offen offset:256 nt
  s_waitcnt vmcnt(7)
  v_lshrrev_b32 v50, 16, v38
  v_dot2c_f32_bf16 v40, v192, v50
  v_dot2c_f32_bf16 v41, v192, v38
  v_dot2c_f32_bf16 v42, v193, v50
  v_dot2c_f32_bf16 v43, v193, v38
  v_dot2c_f32_bf16 v44, v194, v50
  v_dot2c_f32_bf16 v45, v194, v38
  v_dot2c_f32_bf16 v46, v195, v50
  v_dot2c_f32_bf16 v47, v195, v38
  buffer_load_dwordx4 v[224:227], v1, s[44:47], s7 offen offset:512 nt
  s_waitcnt vmcnt(7)
  v_lshrrev_b32 v51, 16, v39
  v_dot2c_f32_bf16 v40, v196, v51
  v_dot2c_f32_bf16 v41, v196, v39
  v_dot2c_f32_bf16 v42, v197, v51
  v_dot2c_f32_bf16 v43, v197, v39
  v_dot2c_f32_bf16 v44, v198, v51
  v_dot2c_f32_bf16 v45, v198, v39
  v_dot2c_f32_bf16 v46, v199, v51
  v_dot2c_f32_bf16 v47, v199, v39
  buffer_load_dwordx4 v[228:231], v1, s[44:47], s7 offen offset:768 nt
  s_waitcnt lgkmcnt(0)
  ds_read_b128 v[36:39], v6 offset:960
  s_waitcnt vmcnt(7)
  v_lshrrev_b32 v50, 16, v32
  v_dot2c_f32_bf16 v40, v200, v50
  v_dot2c_f32_bf16 v41, v200, v32
  v_dot2c_f32_bf16 v42, v201, v50
  v_dot2c_f32_bf16 v43, v201, v32
  v_dot2c_f32_bf16 v44, v202, v50
  v_dot2c_f32_bf16 v45, v202, v32
  v_dot2c_f32_bf16 v46, v203, v50
  v_dot2c_f32_bf16 v47, v203, v32
  s_add_u32 s7, s6, 262144
  buffer_load_dwordx4 v[168:171], v1, s[44:47], s7 offen offset:0 nt
  s_waitcnt vmcnt(7)
  v_lshrrev_b32 v51, 16, v33
  v_dot2c_f32_bf16 v40, v204, v51
  v_dot2c_f32_bf16 v41, v204, v33
  v_dot2c_f32_bf16 v42, v205, v51
  v_dot2c_f32_bf16 v43, v205, v33
  v_dot2c_f32_bf16 v44, v206, v51
  v_dot2c_f32_bf16 v45, v206, v33
  v_dot2c_f32_bf16 v46, v207, v51
  v_dot2c_f32_bf16 v47, v207, v33
  buffer_load_dwordx4 v[172:175], v1, s[44:47], s7 offen offset:256 nt
  s_waitcnt vmcnt(7)
  v_lshrrev_b32 v50, 16, v34
  v_dot2c_f32_bf16 v40, v208, v50
  v_dot2c_f32_bf16 v41, v208, v34
  v_dot2c_f32_bf16 v42, v209, v50
  v_dot2c_f32_bf16 v43, v209, v34
  v_dot2c_f32_bf16 v44, v210, v50
  v_dot2c_f32_bf16 v45, v210, v34
  v_dot2c_f32_bf16 v46, v211, v50
  v_dot2c_f32_bf16 v47, v211, v34
  buffer_load_dwordx4 v[176:179], v1, s[44:47], s7 offen offset:512 nt
  s_waitcnt vmcnt(7)
  v_lshrrev_b32 v51, 16, v35
  v_dot2c_f32_bf16 v40, v212, v51
  v_dot2c_f32_bf16 v41, v212, v35
  v_dot2c_f32_bf16 v42, v213, v51
  v_dot2c_f32_bf16 v43, v213, v35
  v_dot2c_f32_bf16 v44, v214, v51
  v_dot2c_f32_bf16 v45, v214, v35
  v_dot2c_f32_bf16 v46, v215, v51
  v_dot2c_f32_bf16 v47, v215, v35
  buffer_load_dwordx4 v[180:183], v1, s[44:47], s7 offen offset:768 nt
  s_waitcnt lgkmcnt(0)
  ds_read_b128 v[32:35], v6 offset:1024
  s_waitcnt vmcnt(7)
  v_lshrrev_b32 v50, 16, v36
  v_dot2c_f32_bf16 v40, v216, v50
  v_dot2c_f32_bf16 v41, v216, v36
  v_dot2c_f32_bf16 v42, v217, v50
  v_dot2c_f32_bf16 v43, v217, v36
  v_dot2c_f32_bf16 v44, v218, v50
  v_dot2c_f32_bf16 v45, v218, v36
  v_dot2c_f32_bf16 v46, v219, v50
  v_dot2c_f32_bf16 v47, v219, v36
  s_add_u32 s7, s6, 278528
  buffer_load_dwordx4 v[184:187], v1, s[44:47], s7 offen offset:0 nt
  s_waitcnt vmcnt(7)
  v_lshrrev_b32 v51, 16, v37
  v_dot2c_f32_bf16 v40, v220, v51
  v_dot2c_f32_bf16 v41, v220, v37
  v_dot2c_f32_bf16 v42, v221, v51
  v_dot2c_f32_bf16 v43, v221, v37
  v_dot2c_f32_bf16 v44, v222, v51
  v_dot2c_f32_bf16 v45, v222, v37
  v_dot2c_f32_bf16 v46, v223, v51
  v_dot2c_f32_bf16 v47, v223, v37
  buffer_load_dwordx4 v[188:191], v1, s[44:47], s7 offen offset:256 nt
  s_waitcnt vmcnt(7)
  v_lshrrev_b32 v50, 16, v38
  v_dot2c_f32_bf16 v40, v224, v50
  v_dot2c_f32_bf16 v41, v224, v38
  v_dot2c_f32_bf16 v42, v225, v50
  v_dot2c_f32_bf16 v43, v225, v38
  v_dot2c_f32_bf16 v44, v226, v50
  v_dot2c_f32_bf16 v45, v226, v38
  v_dot2c_f32_bf16 v46, v227, v50
  v_dot2c_f32_bf16 v47, v227, v38
  buffer_load_dwordx4 v[192:195], v1, s[44:47], s7 offen offset:512 nt
  s_waitcnt vmcnt(7)
  v_lshrrev_b32 v51, 16, v39
  v_dot2c_f32_bf16 v40, v228, v51
  v_dot2c_f32_bf16 v41, v228, v39
  v_dot2c_f32_bf16 v42, v229, v51
  v_dot2c_f32_bf16 v43, v229, v39
  v_dot2c_f32_bf16 v44, v230, v51
  v_dot2c_f32_bf16 v45, v230, v39
  v_dot2c_f32_bf16 v46, v231, v51
  v_dot2c_f32_bf16 v47, v231, v39
  buffer_load_dwordx4 v[196:199], v1, s[44:47], s7 offen offset:768 nt
  s_waitcnt lgkmcnt(0)
  ds_read_b128 v[36:39], v6 offset:1088
  s_waitcnt vmcnt(7)
  v_lshrrev_b32 v50, 16, v32
  v_dot2c_f32_bf16 v40, v168, v50
  v_dot2c_f32_bf16 v41, v168, v32
  v_dot2c_f32_bf16 v42, v169, v50
  v_dot2c_f32_bf16 v43, v169, v32
  v_dot2c_f32_bf16 v44, v170, v50
  v_dot2c_f32_bf16 v45, v170, v32
  v_dot2c_f32_bf16 v46, v171, v50
  v_dot2c_f32_bf16 v47, v171, v32
  s_add_u32 s7, s6, 294912
  buffer_load_dwordx4 v[200:203], v1, s[44:47], s7 offen offset:0 nt
  buffer_load_dwordx4 v[204:207], v1, s[44:47], s7 offen offset:256 nt
  buffer_load_dwordx4 v[208:211], v1, s[44:47], s7 offen offset:512
  buffer_load_dwordx4 v[212:215], v1, s[44:47], s7 offen offset:768
  s_add_u32 s7, s6, 311296
  buffer_load_dwordx4 v[216:219], v1, s[44:47], s7 offen offset:0
  buffer_load_dwordx4 v[220:223], v1, s[44:47], s7 offen offset:256
  buffer_load_dwordx4 v[224:227], v1, s[44:47], s7 offen offset:512
  buffer_load_dwordx4 v[228:231], v1, s[44:47], s7 offen offset:768
  s_add_u32 s7, s6, 327680
  buffer_load_dwordx4 v[168:171], v1, s[44:47], s7 offen offset:0
  s_waitcnt vmcnt(15)
  v_lshrrev_b32 v51, 16, v33
  v_dot2c_f32_bf16 v40, v172, v51
  v_dot2c_f32_bf16 v41, v172, v33
  v_dot2c_f32_bf16 v42, v173, v51
  v_dot2c_f32_bf16 v43, v173, v33
  v_dot2c_f32_bf16 v44, v174, v51
  v_dot2c_f32_bf16 v45, v174, v33
  v_dot2c_f32_bf16 v46, v175, v51
  v_dot2c_f32_bf16 v47, v175, v33
  buffer_load_dwordx4 v[172:175], v1, s[44:47], s7 offen offset:256
  s_waitcnt vmcnt(15)
  v_lshrrev_b32 v50, 16, v34
  v_dot2c_f32_bf16 v40, v176, v50
  v_dot2c_f32_bf16 v41, v176, v34
  v_dot2c_f32_bf16 v42, v177, v50
  v_dot2c_f32_bf16 v43, v177, v34
  v_dot2c_f32_bf16 v44, v178, v50
  v_dot2c_f32_bf16 v45, v178, v34
  v_dot2c_f32_bf16 v46, v179, v50
  v_dot2c_f32_bf16 v47, v179, v34
  buffer_load_dwordx4 v[176:179], v1, s[44:47], s7 offen offset:512
  s_waitcnt vmcnt(15)
  v_lshrrev_b32 v51, 16, v35
  v_dot2c_f32_bf16 v40, v180, v51
  v_dot2c_f32_bf16 v41, v180, v35
  v_dot2c_f32_bf16 v42, v181, v51
  v_dot2c_f32_bf16 v43, v181, v35
  v_dot2c_f32_bf16 v44, v182, v51
  v_dot2c_f32_bf16 v45, v182, v35
  v_dot2c_f32_bf16 v46, v183, v51
  v_dot2c_f32_bf16 v47, v183, v35
  buffer_load_dwordx4 v[180:183], v1, s[44:47], s7 offen offset:768
  s_waitcnt lgkmcnt(0)
  ds_read_b128 v[32:35], v6 offset:1152
  s_waitcnt vmcnt(15)
  v_lshrrev_b32 v50, 16, v36
  v_dot2c_f32_bf16 v40, v184, v50
  v_dot2c_f32_bf16 v41, v184, v36
  v_dot2c_f32_bf16 v42, v185, v50
  v_dot2c_f32_bf16 v43, v185, v36
  v_dot2c_f32_bf16 v44, v186, v50
  v_dot2c_f32_bf16 v45, v186, v36
  v_dot2c_f32_bf16 v46, v187, v50
  v_dot2c_f32_bf16 v47, v187, v36
  s_add_u32 s7, s6, 344064
  buffer_load_dwordx4 v[184:187], v1, s[44:47], s7 offen offset:0
  s_waitcnt vmcnt(15)
  v_lshrrev_b32 v51, 16, v37
  v_dot2c_f32_bf16 v40, v188, v51
  v_dot2c_f32_bf16 v41, v188, v37
  v_dot2c_f32_bf16 v42, v189, v51
  v_dot2c_f32_bf16 v43, v189, v37
  v_dot2c_f32_bf16 v44, v190, v51
  v_dot2c_f32_bf16 v45, v190, v37
  v_dot2c_f32_bf16 v46, v191, v51
  v_dot2c_f32_bf16 v47, v191, v37
  buffer_load_dwordx4 v[188:191], v1, s[44:47], s7 offen offset:256
  s_waitcnt vmcnt(15)
  v_lshrrev_b32 v50, 16, v38
  v_dot2c_f32_bf16 v40, v192, v50
  v_dot2c_f32_bf16 v41, v192, v38
  v_dot2c_f32_bf16 v42, v193, v50
  v_dot2c_f32_bf16 v43, v193, v38
  v_dot2c_f32_bf16 v44, v194, v50
  v_dot2c_f32_bf16 v45, v194, v38
  v_dot2c_f32_bf16 v46, v195, v50
  v_dot2c_f32_bf16 v47, v195, v38
  buffer_load_dwordx4 v[192:195], v1, s[44:47], s7 offen offset:512
  s_waitcnt vmcnt(15)
  v_lshrrev_b32 v51, 16, v39
  v_dot2c_f32_bf16 v40, v196, v51
  v_dot2c_f32_bf16 v41, v196, v39
  v_dot2c_f32_bf16 v42, v197, v51
  v_dot2c_f32_bf16 v43, v197, v39
  v_dot2c_f32_bf16 v44, v198, v51
  v_dot2c_f32_bf16 v45, v198, v39
  v_dot2c_f32_bf16 v46, v199, v51
  v_dot2c_f32_bf16 v47, v199, v39
  buffer_load_dwordx4 v[196:199], v1, s[44:47], s7 offen offset:768
  s_waitcnt lgkmcnt(0)
  ds_read_b128 v[36:39], v6 offset:1216
  s_waitcnt vmcnt(15)
  v_lshrrev_b32 v50, 16, v32
  v_dot2c_f32_bf16 v40, v200, v50
  v_dot2c_f32_bf16 v41, v200, v32
  v_dot2c_f32_bf16 v42, v201, v50
  v_dot2c_f32_bf16 v43, v201, v32
  v_dot2c_f32_bf16 v44, v202, v50
  v_dot2c_f32_bf16 v45, v202, v32
  v_dot2c_f32_bf16 v46, v203, v50
  v_dot2c_f32_bf16 v47, v203, v32
  s_add_u32 s7, s6, 360448
  buffer_load_dwordx4 v[200:203], v1, s[44:47], s7 offen offset:0
  s_waitcnt vmcnt(15)
  v_lshrrev_b32 v51, 16, v33
  v_dot2c_f32_bf16 v40, v204, v51
  v_dot2c_f32_bf16 v41, v204, v33
  v_dot2c_f32_bf16 v42, v205, v51
  v_dot2c_f32_bf16 v43, v205, v33
  v_dot2c_f32_bf16 v44, v206, v51
  v_dot2c_f32_bf16 v45, v206, v33
  v_dot2c_f32_bf16 v46, v207, v51
  v_dot2c_f32_bf16 v47, v207, v33
  buffer_load_dwordx4 v[204:207], v1, s[44:47], s7 offen offset:256
  s_waitcnt vmcnt(15)
  v_lshrrev_b32 v50, 16, v34
  v_dot2c_f32_bf16 v40, v208, v50
  v_dot2c_f32_bf16 v41, v208, v34
  v_dot2c_f32_bf16 v42, v209, v50
  v_dot2c_f32_bf16 v43, v209, v34
  v_dot2c_f32_bf16 v44, v210, v50
  v_dot2c_f32_bf16 v45, v210, v34
  v_dot2c_f32_bf16 v46, v211, v50
  v_dot2c_f32_bf16 v47, v211, v34
  buffer_load_dwordx4 v[208:211], v1, s[44:47], s7 offen offset:512
  s_waitcnt vmcnt(15)
  v_lshrrev_b32 v51, 16, v35
  v_dot2c_f32_bf16 v40, v212, v51
  v_dot2c_f32_bf16 v41, v212, v35
  v_dot2c_f32_bf16 v42, v213, v51
  v_dot2c_f32_bf16 v43, v213, v35
  v_dot2c_f32_bf16 v44, v214, v51
  v_dot2c_f32_bf16 v45, v214, v35
  v_dot2c_f32_bf16 v46, v215, v51
  v_dot2c_f32_bf16 v47, v215, v35
  buffer_load_dwordx4 v[212:215], v1, s[44:47], s7 offen offset:768
  s_waitcnt lgkmcnt(0)
  ds_read_b128 v[32:35], v6 offset:1280
  s_waitcnt vmcnt(15)
  v_lshrrev_b32 v50, 16, v36
  v_dot2c_f32_bf16 v40, v216, v50
  v_dot2c_f32_bf16 v41, v216, v36
  v_dot2c_f32_bf16 v42, v217, v50
  v_dot2c_f32_bf16 v43, v217, v36
  v_dot2c_f32_bf16 v44, v218, v50
  v_dot2c_f32_bf16 v45, v218, v36
  v_dot2c_f32_bf16 v46, v219, v50
  v_dot2c_f32_bf16 v47, v219, v36
  s_add_u32 s7, s6, 376832
  buffer_load_dwordx4 v[216:219], v1, s[44:47], s7 offen offset:0
  s_waitcnt vmcnt(15)
  v_lshrrev_b32 v51, 16, v37
  v_dot2c_f32_bf16 v40, v220, v51
  v_dot2c_f32_bf16 v41, v220, v37
  v_dot2c_f32_bf16 v42, v221, v51
  v_dot2c_f32_bf16 v43, v221, v37
  v_dot2c_f32_bf16 v44, v222, v51
  v_dot2c_f32_bf16 v45, v222, v37
  v_dot2c_f32_bf16 v46, v223, v51
  v_dot2c_f32_bf16 v47, v223, v37
  buffer_load_dwordx4 v[220:223], v1, s[44:47], s7 offen offset:256
  s_waitcnt vmcnt(15)
  v_lshrrev_b32 v50, 16, v38
  v_dot2c_f32_bf16 v40, v224, v50
  v_dot2c_f32_bf16 v41, v224, v38
  v_dot2c_f32_bf16 v42, v225, v50
  v_dot2c_f32_bf16 v43, v225, v38
  v_dot2c_f32_bf16 v44, v226, v50
  v_dot2c_f32_bf16 v45, v226, v38
  v_dot2c_f32_bf16 v46, v227, v50
  v_dot2c_f32_bf16 v47, v227, v38
  buffer_load_dwordx4 v[224:227], v1, s[44:47], s7 offen offset:512
  s_waitcnt vmcnt(15)
  v_lshrrev_b32 v51, 16, v39
  v_dot2c_f32_bf16 v40, v228, v51
  v_dot2c_f32_bf16 v41, v228, v39
  v_dot2c_f32_bf16 v42, v229, v51
  v_dot2c_f32_bf16 v43, v229, v39
  v_dot2c_f32_bf16 v44, v230, v51
  v_dot2c_f32_bf16 v45, v230, v39
  v_dot2c_f32_bf16 v46, v231, v51
  v_dot2c_f32_bf16 v47, v231, v39
  buffer_load_dwordx4 v[228:231], v1, s[44:47], s7 offen offset:768
  s_waitcnt lgkmcnt(0)
  ds_read_b128 v[36:39], v6 offset:1344
  v_and_b32 v4, 7, v0
  v_lshlrev_b32 v4, 5, v4
  global_load_dword v55, v4, s[36:37] sc1
  s_waitcnt vmcnt(16)
  v_lshrrev_b32 v50, 16, v32
  v_dot2c_f32_bf16 v40, v168, v50
  v_dot2c_f32_bf16 v41, v168, v32
  v_dot2c_f32_bf16 v42, v169, v50
  v_dot2c_f32_bf16 v43, v169, v32
  v_dot2c_f32_bf16 v44, v170, v50
  v_dot2c_f32_bf16 v45, v170, v32
  v_dot2c_f32_bf16 v46, v171, v50
  v_dot2c_f32_bf16 v47, v171, v32
  s_add_u32 s7, s6, 393216
  buffer_load_dwordx4 v[168:171], v1, s[44:47], s7 offen offset:0
  s_waitcnt vmcnt(16)
  v_lshrrev_b32 v51, 16, v33
  v_dot2c_f32_bf16 v40, v172, v51
  v_dot2c_f32_bf16 v41, v172, v33
  v_dot2c_f32_bf16 v42, v173, v51
  v_dot2c_f32_bf16 v43, v173, v33
  v_dot2c_f32_bf16 v44, v174, v51
  v_dot2c_f32_bf16 v45, v174, v33
  v_dot2c_f32_bf16 v46, v175, v51
  v_dot2c_f32_bf16 v47, v175, v33
  buffer_load_dwordx4 v[172:175], v1, s[44:47], s7 offen offset:256
  s_waitcnt vmcnt(16)
  v_lshrrev_b32 v50, 16, v34
  v_dot2c_f32_bf16 v40, v176, v50
  v_dot2c_f32_bf16 v41, v176, v34
  v_dot2c_f32_bf16 v42, v177, v50
  v_dot2c_f32_bf16 v43, v177, v34
  v_dot2c_f32_bf16 v44, v178, v50
  v_dot2c_f32_bf16 v45, v178, v34
  v_dot2c_f32_bf16 v46, v179, v50
  v_dot2c_f32_bf16 v47, v179, v34
  buffer_load_dwordx4 v[176:179], v1, s[44:47], s7 offen offset:512
  s_waitcnt vmcnt(16)
  v_lshrrev_b32 v51, 16, v35
  v_dot2c_f32_bf16 v40, v180, v51
  v_dot2c_f32_bf16 v41, v180, v35
  v_dot2c_f32_bf16 v42, v181, v51
  v_dot2c_f32_bf16 v43, v181, v35
  v_dot2c_f32_bf16 v44, v182, v51
  v_dot2c_f32_bf16 v45, v182, v35
  v_dot2c_f32_bf16 v46, v183, v51
  v_dot2c_f32_bf16 v47, v183, v35
  buffer_load_dwordx4 v[180:183], v1, s[44:47], s7 offen offset:768
  s_waitcnt lgkmcnt(0)
  ds_read_b128 v[32:35], v6 offset:1408
  s_waitcnt vmcnt(16)
  v_lshrrev_b32 v50, 16, v36
  v_dot2c_f32_bf16 v40, v184, v50
  v_dot2c_f32_bf16 v41, v184, v36
  v_dot2c_f32_bf16 v42, v185, v50
  v_dot2c_f32_bf16 v43, v185, v36
  v_dot2c_f32_bf16 v44, v186, v50
  v_dot2c_f32_bf16 v45, v186, v36
  v_dot2c_f32_bf16 v46, v187, v50
  v_dot2c_f32_bf16 v47, v187, v36
  s_add_u32 s7, s6, 409600
  buffer_load_dwordx4 v[184:187], v1, s[44:47], s7 offen offset:0
  s_waitcnt vmcnt(16)
  v_lshrrev_b32 v51, 16, v37
  v_dot2c_f32_bf16 v40, v188, v51
  v_dot2c_f32_bf16 v41, v188, v37
  v_dot2c_f32_bf16 v42, v189, v51
  v_dot2c_f32_bf16 v43, v189, v37
  v_dot2c_f32_bf16 v44, v190, v51
  v_dot2c_f32_bf16 v45, v190, v37
  v_dot2c_f32_bf16 v46, v191, v51
  v_dot2c_f32_bf16 v47, v191, v37
  buffer_load_dwordx4 v[188:191], v1, s[44:47], s7 offen offset:256
  s_waitcnt vmcnt(16)
  v_lshrrev_b32 v50, 16, v38
  v_dot2c_f32_bf16 v40, v192, v50
  v_dot2c_f32_bf16 v41, v192, v38
  v_dot2c_f32_bf16 v42, v193, v50
  v_dot2c_f32_bf16 v43, v193, v38
  v_dot2c_f32_bf16 v44, v194, v50
  v_dot2c_f32_bf16 v45, v194, v38
  v_dot2c_f32_bf16 v46, v195, v50
  v_dot2c_f32_bf16 v47, v195, v38
  buffer_load_dwordx4 v[192:195], v1, s[44:47], s7 offen offset:512
  s_waitcnt vmcnt(16)
  v_lshrrev_b32 v51, 16, v39
  v_dot2c_f32_bf16 v40, v196, v51
  v_dot2c_f32_bf16 v41, v196, v39
  v_dot2c_f32_bf16 v42, v197, v51
  v_dot2c_f32_bf16 v43, v197, v39
  v_dot2c_f32_bf16 v44, v198, v51
  v_dot2c_f32_bf16 v45, v198, v39
  v_dot2c_f32_bf16 v46, v199, v51
  v_dot2c_f32_bf16 v47, v199, v39
  buffer_load_dwordx4 v[196:199], v1, s[44:47], s7 offen offset:768
  s_waitcnt lgkmcnt(0)
  ds_read_b128 v[36:39], v6 offset:1472
  s_waitcnt vmcnt(16)
  v_lshrrev_b32 v50, 16, v32
  v_dot2c_f32_bf16 v40, v200, v50
  v_dot2c_f32_bf16 v41, v200, v32
  v_dot2c_f32_bf16 v42, v201, v50
  v_dot2c_f32_bf16 v43, v201, v32
  v_dot2c_f32_bf16 v44, v202, v50
  v_dot2c_f32_bf16 v45, v202, v32
  v_dot2c_f32_bf16 v46, v203, v50
  v_dot2c_f32_bf16 v47, v203, v32
  s_add_u32 s7, s6, 425984
  buffer_load_dwordx4 v[200:203], v1, s[44:47], s7 offen offset:0
  s_waitcnt vmcnt(16)
  v_lshrrev_b32 v51, 16, v33
  v_dot2c_f32_bf16 v40, v204, v51
  v_dot2c_f32_bf16 v41, v204, v33
  v_dot2c_f32_bf16 v42, v205, v51
  v_dot2c_f32_bf16 v43, v205, v33
  v_dot2c_f32_bf16 v44, v206, v51
  v_dot2c_f32_bf16 v45, v206, v33
  v_dot2c_f32_bf16 v46, v207, v51
  v_dot2c_f32_bf16 v47, v207, v33
  buffer_load_dwordx4 v[204:207], v1, s[44:47], s7 offen offset:256
  s_waitcnt vmcnt(16)
  v_lshrrev_b32 v50, 16, v34
  v_dot2c_f32_bf16 v40, v208, v50
  v_dot2c_f32_bf16 v41, v208, v34
  v_dot2c_f32_bf16 v42, v209, v50
  v_dot2c_f32_bf16 v43, v209, v34
  v_dot2c_f32_bf16 v44, v210, v50
  v_dot2c_f32_bf16 v45, v210, v34
  v_dot2c_f32_bf16 v46, v211, v50
  v_dot2c_f32_bf16 v47, v211, v34
  buffer_load_dwordx4 v[208:211], v1, s[44:47], s7 offen offset:512
  s_waitcnt vmcnt(16)
  v_lshrrev_b32 v51, 16, v35
  v_dot2c_f32_bf16 v40, v212, v51
  v_dot2c_f32_bf16 v41, v212, v35
  v_dot2c_f32_bf16 v42, v213, v51
  v_dot2c_f32_bf16 v43, v213, v35
  v_dot2c_f32_bf16 v44, v214, v51
  v_dot2c_f32_bf16 v45, v214, v35
  v_dot2c_f32_bf16 v46, v215, v51
  v_dot2c_f32_bf16 v47, v215, v35
  buffer_load_dwordx4 v[212:215], v1, s[44:47], s7 offen offset:768
  s_waitcnt lgkmcnt(0)
  ds_read_b128 v[32:35], v6 offset:1536
  s_waitcnt vmcnt(16)
  v_lshrrev_b32 v50, 16, v36
  v_dot2c_f32_bf16 v40, v216, v50
  v_dot2c_f32_bf16 v41, v216, v36
  v_dot2c_f32_bf16 v42, v217, v50
  v_dot2c_f32_bf16 v43, v217, v36
  v_dot2c_f32_bf16 v44, v218, v50
  v_dot2c_f32_bf16 v45, v218, v36
  v_dot2c_f32_bf16 v46, v219, v50
  v_dot2c_f32_bf16 v47, v219, v36
  s_add_u32 s7, s6, 442368
  buffer_load_dwordx4 v[216:219], v1, s[44:47], s7 offen offset:0
  s_waitcnt vmcnt(16)
  v_lshrrev_b32 v51, 16, v37
  v_dot2c_f32_bf16 v40, v220, v51
  v_dot2c_f32_bf16 v41, v220, v37
  v_dot2c_f32_bf16 v42, v221, v51
  v_dot2c_f32_bf16 v43, v221, v37
  v_dot2c_f32_bf16 v44, v222, v51
  v_dot2c_f32_bf16 v45, v222, v37
  v_dot2c_f32_bf16 v46, v223, v51
  v_dot2c_f32_bf16 v47, v223, v37
  buffer_load_dwordx4 v[220:223], v1, s[44:47], s7 offen offset:256
  s_add_u32 m0, s49, 37376
  s_nop 0
  buffer_load_dwordx4 v1, s[44:47], s7 offen offset:512 nt lds
  s_add_u32 m0, s49, 38144
  s_nop 0
  buffer_load_dwordx4 v1, s[44:47], s7 offen offset:768 nt lds
  s_waitcnt vmcnt(18)
  v_lshrrev_b32 v50, 16, v38
  v_dot2c_f32_bf16 v40, v224, v50
  v_dot2c_f32_bf16 v41, v224, v38
  v_dot2c_f32_bf16 v42, v225, v50
  v_dot2c_f32_bf16 v43, v225, v38
  v_dot2c_f32_bf16 v44, v226, v50
  v_dot2c_f32_bf16 v45, v226, v38
  v_dot2c_f32_bf16 v46, v227, v50
  v_dot2c_f32_bf16 v47, v227, v38
  s_waitcnt vmcnt(17)
  v_lshrrev_b32 v51, 16, v39
  v_dot2c_f32_bf16 v40, v228, v51
  v_dot2c_f32_bf16 v41, v228, v39
  v_dot2c_f32_bf16 v42, v229, v51
  v_dot2c_f32_bf16 v43, v229, v39
  v_dot2c_f32_bf16 v44, v230, v51
  v_dot2c_f32_bf16 v45, v230, v39
  v_dot2c_f32_bf16 v46, v231, v51
  v_dot2c_f32_bf16 v47, v231, v39
  s_waitcnt lgkmcnt(0)
  ds_read_b128 v[36:39], v6 offset:1600
  s_waitcnt vmcnt(15)
  v_lshrrev_b32 v50, 16, v32
  v_dot2c_f32_bf16 v40, v168, v50
  v_dot2c_f32_bf16 v41, v168, v32
  v_dot2c_f32_bf16 v42, v169, v50
  v_dot2c_f32_bf16 v43, v169, v32
  v_dot2c_f32_bf16 v44, v170, v50
  v_dot2c_f32_bf16 v45, v170, v32
  v_dot2c_f32_bf16 v46, v171, v50
  v_dot2c_f32_bf16 v47, v171, v32
  s_add_u32 s7, s6, 458752
  buffer_load_dwordx4 v[168:171], v1, s[44:47], s7 offen offset:0 nt
  s_waitcnt vmcnt(15)
  v_lshrrev_b32 v51, 16, v33
  v_dot2c_f32_bf16 v40, v172, v51
  v_dot2c_f32_bf16 v41, v172, v33
  v_dot2c_f32_bf16 v42, v173, v51
  v_dot2c_f32_bf16 v43, v173, v33
  v_dot2c_f32_bf16 v44, v174, v51
  v_dot2c_f32_bf16 v45, v174, v33
  v_dot2c_f32_bf16 v46, v175, v51
  v_dot2c_f32_bf16 v47, v175, v33
  buffer_load_dwordx4 v[172:175], v1, s[44:47], s7 offen offset:256 nt
  s_waitcnt vmcnt(15)
  v_lshrrev_b32 v50, 16, v34
  v_dot2c_f32_bf16 v40, v176, v50
  v_dot2c_f32_bf16 v41, v176, v34
  v_dot2c_f32_bf16 v42, v177, v50
  v_dot2c_f32_bf16 v43, v177, v34
  v_dot2c_f32_bf16 v44, v178, v50
  v_dot2c_f32_bf16 v45, v178, v34
  v_dot2c_f32_bf16 v46, v179, v50
  v_dot2c_f32_bf16 v47, v179, v34
  buffer_load_dwordx4 v[176:179], v1, s[44:47], s7 offen offset:512 nt
  s_waitcnt vmcnt(15)
  v_lshrrev_b32 v51, 16, v35
  v_dot2c_f32_bf16 v40, v180, v51
  v_dot2c_f32_bf16 v41, v180, v35
  v_dot2c_f32_bf16 v42, v181, v51
  v_dot2c_f32_bf16 v43, v181, v35
  v_dot2c_f32_bf16 v44, v182, v51
  v_dot2c_f32_bf16 v45, v182, v35
  v_dot2c_f32_bf16 v46, v183, v51
  v_dot2c_f32_bf16 v47, v183, v35
  buffer_load_dwordx4 v[180:183], v1, s[44:47], s7 offen offset:768 nt
  s_waitcnt lgkmcnt(0)
  ds_read_b128 v[32:35], v6 offset:1664
  s_waitcnt vmcnt(15)
  v_lshrrev_b32 v50, 16, v36
  v_dot2c_f32_bf16 v40, v184, v50
  v_dot2c_f32_bf16 v41, v184, v36
  v_dot2c_f32_bf16 v42, v185, v50
  v_dot2c_f32_bf16 v43, v185, v36
  v_dot2c_f32_bf16 v44, v186, v50
  v_dot2c_f32_bf16 v45, v186, v36
  v_dot2c_f32_bf16 v46, v187, v50
  v_dot2c_f32_bf16 v47, v187, v36
  s_add_u32 s7, s6, 475136
  buffer_load_dwordx4 v[184:187], v1, s[44:47], s7 offen offset:0 nt
  s_waitcnt vmcnt(15)
  v_lshrrev_b32 v51, 16, v37
  v_dot2c_f32_bf16 v40, v188, v51
  v_dot2c_f32_bf16 v41, v188, v37
  v_dot2c_f32_bf16 v42, v189, v51
  v_dot2c_f32_bf16 v43, v189, v37
  v_dot2c_f32_bf16 v44, v190, v51
  v_dot2c_f32_bf16 v45, v190, v37
  v_dot2c_f32_bf16 v46, v191, v51
  v_dot2c_f32_bf16 v47, v191, v37
  buffer_load_dwordx4 v[188:191], v1, s[44:47], s7 offen offset:256 nt
  s_waitcnt vmcnt(15)
  v_lshrrev_b32 v50, 16, v38
  v_dot2c_f32_bf16 v40, v192, v50
  v_dot2c_f32_bf16 v41, v192, v38
  v_dot2c_f32_bf16 v42, v193, v50
  v_dot2c_f32_bf16 v43, v193, v38
  v_dot2c_f32_bf16 v44, v194, v50
  v_dot2c_f32_bf16 v45, v194, v38
  v_dot2c_f32_bf16 v46, v195, v50
  v_dot2c_f32_bf16 v47, v195, v38
  buffer_load_dwordx4 v[192:195], v1, s[44:47], s7 offen offset:512 nt
  s_waitcnt vmcnt(15)
  v_lshrrev_b32 v51, 16, v39
  v_dot2c_f32_bf16 v40, v196, v51
  v_dot2c_f32_bf16 v41, v196, v39
  v_dot2c_f32_bf16 v42, v197, v51
  v_dot2c_f32_bf16 v43, v197, v39
  v_dot2c_f32_bf16 v44, v198, v51
  v_dot2c_f32_bf16 v45, v198, v39
  v_dot2c_f32_bf16 v46, v199, v51
  v_dot2c_f32_bf16 v47, v199, v39
  buffer_load_dwordx4 v[196:199], v1, s[44:47], s7 offen offset:768 nt
  s_waitcnt lgkmcnt(0)
  ds_read_b128 v[36:39], v6 offset:1728
  s_waitcnt vmcnt(15)
  v_lshrrev_b32 v50, 16, v32
  v_dot2c_f32_bf16 v40, v200, v50
  v_dot2c_f32_bf16 v41, v200, v32
  v_dot2c_f32_bf16 v42, v201, v50
  v_dot2c_f32_bf16 v43, v201, v32
  v_dot2c_f32_bf16 v44, v202, v50
  v_dot2c_f32_bf16 v45, v202, v32
  v_dot2c_f32_bf16 v46, v203, v50
  v_dot2c_f32_bf16 v47, v203, v32
  s_add_u32 s7, s6, 491520
  buffer_load_dwordx4 v[200:203], v1, s[44:47], s7 offen offset:0 nt
  s_waitcnt vmcnt(15)
  v_lshrrev_b32 v51, 16, v33
  v_dot2c_f32_bf16 v40, v204, v51
  v_dot2c_f32_bf16 v41, v204, v33
  v_dot2c_f32_bf16 v42, v205, v51
  v_dot2c_f32_bf16 v43, v205, v33
  v_dot2c_f32_bf16 v44, v206, v51
  v_dot2c_f32_bf16 v45, v206, v33
  v_dot2c_f32_bf16 v46, v207, v51
  v_dot2c_f32_bf16 v47, v207, v33
  buffer_load_dwordx4 v[204:207], v1, s[44:47], s7 offen offset:256 nt
  s_waitcnt vmcnt(15)
  v_lshrrev_b32 v50, 16, v34
  v_dot2c_f32_bf16 v40, v208, v50
  v_dot2c_f32_bf16 v41, v208, v34
  v_dot2c_f32_bf16 v42, v209, v50
  v_dot2c_f32_bf16 v43, v209, v34
  v_dot2c_f32_bf16 v44, v210, v50
  v_dot2c_f32_bf16 v45, v210, v34
  v_dot2c_f32_bf16 v46, v211, v50
  v_dot2c_f32_bf16 v47, v211, v34
  buffer_load_dwordx4 v[208:211], v1, s[44:47], s7 offen offset:512 nt
  s_waitcnt vmcnt(15)
  v_lshrrev_b32 v51, 16, v35
  v_dot2c_f32_bf16 v40, v212, v51
  v_dot2c_f32_bf16 v41, v212, v35
  v_dot2c_f32_bf16 v42, v213, v51
  v_dot2c_f32_bf16 v43, v213, v35
  v_dot2c_f32_bf16 v44, v214, v51
  v_dot2c_f32_bf16 v45, v214, v35
  v_dot2c_f32_bf16 v46, v215, v51
  v_dot2c_f32_bf16 v47, v215, v35
  buffer_load_dwordx4 v[212:215], v1, s[44:47], s7 offen offset:768 nt
  s_waitcnt lgkmcnt(0)
  ds_read_b128 v[32:35], v6 offset:1792
  s_waitcnt vmcnt(15)
  v_lshrrev_b32 v50, 16, v36
  v_dot2c_f32_bf16 v40, v216, v50
  v_dot2c_f32_bf16 v41, v216, v36
  v_dot2c_f32_bf16 v42, v217, v50
  v_dot2c_f32_bf16 v43, v217, v36
  v_dot2c_f32_bf16 v44, v218, v50
  v_dot2c_f32_bf16 v45, v218, v36
  v_dot2c_f32_bf16 v46, v219, v50
  v_dot2c_f32_bf16 v47, v219, v36
  s_add_u32 s7, s6, 507904
  buffer_load_dwordx4 v[216:219], v1, s[44:47], s7 offen offset:0 nt
  s_waitcnt vmcnt(15)
  v_lshrrev_b32 v51, 16, v37
  v_dot2c_f32_bf16 v40, v220, v51
  v_dot2c_f32_bf16 v41, v220, v37
  v_dot2c_f32_bf16 v42, v221, v51
  v_dot2c_f32_bf16 v43, v221, v37
  v_dot2c_f32_bf16 v44, v222, v51
  v_dot2c_f32_bf16 v45, v222, v37
  v_dot2c_f32_bf16 v46, v223, v51
  v_dot2c_f32_bf16 v47, v223, v37
  buffer_load_dwordx4 v[220:223], v1, s[44:47], s7 offen offset:256 nt
  buffer_load_dwordx4 v[224:227], v1, s[44:47], s7 offen offset:512 nt
  buffer_load_dwordx4 v[228:231], v1, s[44:47], s7 offen offset:768 nt
  s_waitcnt vmcnt(17)
  ds_read_b128 v[24:27], v7 offset:37888
  s_waitcnt lgkmcnt(0)
  v_lshrrev_b32 v50, 16, v38
  v_dot2c_f32_bf16 v40, v24, v50
  v_dot2c_f32_bf16 v41, v24, v38
  v_dot2c_f32_bf16 v42, v25, v50
  v_dot2c_f32_bf16 v43, v25, v38
  v_dot2c_f32_bf16 v44, v26, v50
  v_dot2c_f32_bf16 v45, v26, v38
  v_dot2c_f32_bf16 v46, v27, v50
  v_dot2c_f32_bf16 v47, v27, v38
  s_waitcnt vmcnt(16)
  ds_read_b128 v[28:31], v7 offset:38912
  s_waitcnt lgkmcnt(0)
  v_lshrrev_b32 v51, 16, v39
  v_dot2c_f32_bf16 v40, v28, v51
  v_dot2c_f32_bf16 v41, v28, v39
  v_dot2c_f32_bf16 v42, v29, v51
  v_dot2c_f32_bf16 v43, v29, v39
  v_dot2c_f32_bf16 v44, v30, v51
  v_dot2c_f32_bf16 v45, v30, v39
  v_dot2c_f32_bf16 v46, v31, v51
  v_dot2c_f32_bf16 v47, v31, v39
  s_waitcnt lgkmcnt(0)
  ds_read_b128 v[36:39], v6 offset:1856
  v_cmp_gt_u32 vcc, 32, v55
  s_cmp_eq_u64 vcc, 0
  s_cselect_b32 s51, 1, 0
  v_and_b32 v4, 7, v0
  v_lshlrev_b32 v4, 14, v4
  s_lshl_b32 s12, s4, 9
  s_lshl_b32 s13, s3, 7
  s_add_u32 s12, s12, s13
  v_add_u32 v4, s12, v4
  global_load_dword v53, v4, s[26:27] offset:4 sc1
  s_waitcnt vmcnt(16)
  v_lshrrev_b32 v50, 16, v32
  v_dot2c_f32_bf16 v40, v168, v50
  v_dot2c_f32_bf16 v41, v168, v32
  v_dot2c_f32_bf16 v42, v169, v50
  v_dot2c_f32_bf16 v43, v169, v32
  v_dot2c_f32_bf16 v44, v170, v50
  v_dot2c_f32_bf16 v45, v170, v32
  v_dot2c_f32_bf16 v46, v171, v50
  v_dot2c_f32_bf16 v47, v171, v32
  s_waitcnt vmcnt(15)
  v_lshrrev_b32 v51, 16, v33
  v_dot2c_f32_bf16 v40, v172, v51
  v_dot2c_f32_bf16 v41, v172, v33
  v_dot2c_f32_bf16 v42, v173, v51
  v_dot2c_f32_bf16 v43, v173, v33
  v_dot2c_f32_bf16 v44, v174, v51
  v_dot2c_f32_bf16 v45, v174, v33
  v_dot2c_f32_bf16 v46, v175, v51
  v_dot2c_f32_bf16 v47, v175, v33
  s_waitcnt vmcnt(14)
  v_lshrrev_b32 v50, 16, v34
  v_dot2c_f32_bf16 v40, v176, v50
  v_dot2c_f32_bf16 v41, v176, v34
  v_dot2c_f32_bf16 v42, v177, v50
  v_dot2c_f32_bf16 v43, v177, v34
  v_dot2c_f32_bf16 v44, v178, v50
  v_dot2c_f32_bf16 v45, v178, v34
  v_dot2c_f32_bf16 v46, v179, v50
  v_dot2c_f32_bf16 v47, v179, v34
  s_waitcnt vmcnt(13)
  v_lshrrev_b32 v51, 16, v35
  v_dot2c_f32_bf16 v40, v180, v51
  v_dot2c_f32_bf16 v41, v180, v35
  v_dot2c_f32_bf16 v42, v181, v51
  v_dot2c_f32_bf16 v43, v181, v35
  v_dot2c_f32_bf16 v44, v182, v51
  v_dot2c_f32_bf16 v45, v182, v35
  v_dot2c_f32_bf16 v46, v183, v51
  v_dot2c_f32_bf16 v47, v183, v35
  s_waitcnt lgkmcnt(0)
  ds_read_b128 v[32:35], v6 offset:1920
  s_waitcnt vmcnt(12)
  v_lshrrev_b32 v50, 16, v36
  v_dot2c_f32_bf16 v40, v184, v50
  v_dot2c_f32_bf16 v41, v184, v36
  v_dot2c_f32_bf16 v42, v185, v50
  v_dot2c_f32_bf16 v43, v185, v36
  v_dot2c_f32_bf16 v44, v186, v50
  v_dot2c_f32_bf16 v45, v186, v36
  v_dot2c_f32_bf16 v46, v187, v50
  v_dot2c_f32_bf16 v47, v187, v36
  s_waitcnt vmcnt(11)
  v_lshrrev_b32 v51, 16, v37
  v_dot2c_f32_bf16 v40, v188, v51
  v_dot2c_f32_bf16 v41, v188, v37
  v_dot2c_f32_bf16 v42, v189, v51
  v_dot2c_f32_bf16 v43, v189, v37
  v_dot2c_f32_bf16 v44, v190, v51
  v_dot2c_f32_bf16 v45, v190, v37
  v_dot2c_f32_bf16 v46, v191, v51
  v_dot2c_f32_bf16 v47, v191, v37
  s_waitcnt vmcnt(10)
  v_lshrrev_b32 v50, 16, v38
  v_dot2c_f32_bf16 v40, v192, v50
  v_dot2c_f32_bf16 v41, v192, v38
  v_dot2c_f32_bf16 v42, v193, v50
  v_dot2c_f32_bf16 v43, v193, v38
  v_dot2c_f32_bf16 v44, v194, v50
  v_dot2c_f32_bf16 v45, v194, v38
  v_dot2c_f32_bf16 v46, v195, v50
  v_dot2c_f32_bf16 v47, v195, v38
  s_waitcnt vmcnt(9)
  v_lshrrev_b32 v51, 16, v39
  v_dot2c_f32_bf16 v40, v196, v51
  v_dot2c_f32_bf16 v41, v196, v39
  v_dot2c_f32_bf16 v42, v197, v51
  v_dot2c_f32_bf16 v43, v197, v39
  v_dot2c_f32_bf16 v44, v198, v51
  v_dot2c_f32_bf16 v45, v198, v39
  v_dot2c_f32_bf16 v46, v199, v51
  v_dot2c_f32_bf16 v47, v199, v39
  s_waitcnt lgkmcnt(0)
  ds_read_b128 v[36:39], v6 offset:1984
  s_waitcnt vmcnt(8)
  v_lshrrev_b32 v50, 16, v32
  v_dot2c_f32_bf16 v40, v200, v50
  v_dot2c_f32_bf16 v41, v200, v32
  v_dot2c_f32_bf16 v42, v201, v50
  v_dot2c_f32_bf16 v43, v201, v32
  v_dot2c_f32_bf16 v44, v202, v50
  v_dot2c_f32_bf16 v45, v202, v32
  v_dot2c_f32_bf16 v46, v203, v50
  v_dot2c_f32_bf16 v47, v203, v32
  s_waitcnt vmcnt(7)
  v_lshrrev_b32 v51, 16, v33
  v_dot2c_f32_bf16 v40, v204, v51
  v_dot2c_f32_bf16 v41, v204, v33
  v_dot2c_f32_bf16 v42, v205, v51
  v_dot2c_f32_bf16 v43, v205, v33
  v_dot2c_f32_bf16 v44, v206, v51
  v_dot2c_f32_bf16 v45, v206, v33
  v_dot2c_f32_bf16 v46, v207, v51
  v_dot2c_f32_bf16 v47, v207, v33
  s_waitcnt vmcnt(6)
  v_lshrrev_b32 v50, 16, v34
  v_dot2c_f32_bf16 v40, v208, v50
  v_dot2c_f32_bf16 v41, v208, v34
  v_dot2c_f32_bf16 v42, v209, v50
  v_dot2c_f32_bf16 v43, v209, v34
  v_dot2c_f32_bf16 v44, v210, v50
  v_dot2c_f32_bf16 v45, v210, v34
  v_dot2c_f32_bf16 v46, v211, v50
  v_dot2c_f32_bf16 v47, v211, v34
  s_waitcnt vmcnt(5)
  v_lshrrev_b32 v51, 16, v35
  v_dot2c_f32_bf16 v40, v212, v51
  v_dot2c_f32_bf16 v41, v212, v35
  v_dot2c_f32_bf16 v42, v213, v51
  v_dot2c_f32_bf16 v43, v213, v35
  v_dot2c_f32_bf16 v44, v214, v51
  v_dot2c_f32_bf16 v45, v214, v35
  v_dot2c_f32_bf16 v46, v215, v51
  v_dot2c_f32_bf16 v47, v215, v35
  s_waitcnt lgkmcnt(0)
  s_waitcnt vmcnt(4)
  v_lshrrev_b32 v50, 16, v36
  v_dot2c_f32_bf16 v40, v216, v50
  v_dot2c_f32_bf16 v41, v216, v36
  v_dot2c_f32_bf16 v42, v217, v50
  v_dot2c_f32_bf16 v43, v217, v36
  v_dot2c_f32_bf16 v44, v218, v50
  v_dot2c_f32_bf16 v45, v218, v36
  v_dot2c_f32_bf16 v46, v219, v50
  v_dot2c_f32_bf16 v47, v219, v36
  s_waitcnt vmcnt(3)
  v_lshrrev_b32 v51, 16, v37
  v_dot2c_f32_bf16 v40, v220, v51
  v_dot2c_f32_bf16 v41, v220, v37
  v_dot2c_f32_bf16 v42, v221, v51
  v_dot2c_f32_bf16 v43, v221, v37
  v_dot2c_f32_bf16 v44, v222, v51
  v_dot2c_f32_bf16 v45, v222, v37
  v_dot2c_f32_bf16 v46, v223, v51
  v_dot2c_f32_bf16 v47, v223, v37
  s_waitcnt vmcnt(2)
  v_lshrrev_b32 v50, 16, v38
  v_dot2c_f32_bf16 v40, v224, v50
  v_dot2c_f32_bf16 v41, v224, v38
  v_dot2c_f32_bf16 v42, v225, v50
  v_dot2c_f32_bf16 v43, v225, v38
  v_dot2c_f32_bf16 v44, v226, v50
  v_dot2c_f32_bf16 v45, v226, v38
  v_dot2c_f32_bf16 v46, v227, v50
  v_dot2c_f32_bf16 v47, v227, v38
  s_waitcnt vmcnt(1)
  v_lshrrev_b32 v51, 16, v39
  v_dot2c_f32_bf16 v40, v228, v51
  v_dot2c_f32_bf16 v41, v228, v39
  v_dot2c_f32_bf16 v42, v229, v51
  v_dot2c_f32_bf16 v43, v229, v39
  v_dot2c_f32_bf16 v44, v230, v51
  v_dot2c_f32_bf16 v45, v230, v39
  v_dot2c_f32_bf16 v46, v231, v51
  v_dot2c_f32_bf16 v47, v231, v39
  s_waitcnt vmcnt(0)
  v_cmp_ne_u32 vcc, s76, v53
  s_cmp_eq_u64 vcc, 0
  s_cselect_b32 s75, s51, 0
L_chain:
  s_nop 4
  s_mul_i32 s12, s10, 622592
  s_add_u32 s14, s38, s12
  s_addc_u32 s15, s39, 0
  v_permlane32_swap_b32 v40, v44
  v_permlane32_swap_b32 v41, v45
  v_permlane32_swap_b32 v42, v46
  v_permlane32_swap_b32 v43, v47
  v_add_f32 v40, v40, v44
  v_add_f32 v41, v41, v45
  v_add_f32 v42, v42, v46
  v_add_f32 v43, v43, v47
  s_nop 0
  v_permlane16_swap_b32 v40, v42
  v_permlane16_swap_b32 v41, v43
  v_add_f32 v40, v40, v42
  v_add_f32 v41, v41, v43
  v_and_b32 v4, 15, v0
  v_lshlrev_b32 v4, 5, v4
  v_lshrrev_b32 v5, 4, v0
  v_lshl_add_u32 v4, v5, 3, v4
  s_lshl_b32 s12, s3, 11
  v_add_u32 v4, s12, v4
  ds_write_b64 v4, v[40:41] offset:0
  v_mov_b32 v4, s12
  ds_write_b64 v4, v[48:49] offset:512
  s_waitcnt lgkmcnt(0)
  s_barrier
  s_cmp_lg_u32 s3, 0
  s_cbranch_scc1 L_nw0_6
  s_cmp_lg_u32 s51, 0
  s_cbranch_scc1 L_chkd_8
  v_and_b32 v4, 7, v0
  v_lshlrev_b32 v4, 5, v4
L_chk_7:
  s_nop 4
  global_load_dword v5, v4, s[36:37] sc1
  s_waitcnt vmcnt(0)
  v_cmp_gt_u32 vcc, 32, v5
  s_sub_u32 s11, s11, 1
  s_cbranch_scc1 L_end
  s_cbranch_vccnz L_chk_7
L_chkd_8:
  s_nop 4
  v_lshlrev_b32 v4, 3, v0
  v_mov_b32 v5, 0
  ds_read_b64 v[40:41], v4 offset:0
  ds_read_b64 v[42:43], v4 offset:2048
  ds_read_b64 v[44:45], v4 offset:4096
  ds_read_b64 v[46:47], v4 offset:6144
  ds_read_b64 v[48:49], v5 offset:512
  ds_read_b64 v[50:51], v5 offset:2560
  ds_read_b64 v[52:53], v5 offset:4608
  ds_read_b64 v[54:55], v5 offset:6656
  s_waitcnt lgkmcnt(0)
  v_max_f32 v6, v48, v50
  v_max3_f32 v6, v6, v52, v54
  v_sub_f32 v48, v48, v6
  v_sub_f32 v50, v50, v6
  v_sub_f32 v52, v52, v6
  v_sub_f32 v54, v54, v6
  v_mul_f32 v48, s8, v48
  v_mul_f32 v50, s8, v50
  v_mul_f32 v52, s8, v52
  v_mul_f32 v54, s8, v54
  v_exp_f32 v48, v48
  v_exp_f32 v50, v50
  v_exp_f32 v52, v52
  v_exp_f32 v54, v54
  v_mul_f32 v4, v40, v48
  v_mul_f32 v5, v41, v48
  v_mul_f32 v7, v49, v48
  v_fmac_f32 v4, v42, v50
  v_fmac_f32 v5, v43, v50
  v_fmac_f32 v7, v51, v50
  v_fmac_f32 v4, v44, v52
  v_fmac_f32 v5, v45, v52
  v_fmac_f32 v7, v53, v52
  v_fmac_f32 v4, v46, v54
  v_fmac_f32 v5, v47, v54
  v_fmac_f32 v7, v55, v54
  v_min_u32 v4, -2, v4
  v_min_u32 v5, -2, v5
  v_min_u32 v6, -2, v6
  v_min_u32 v7, -2, v7
  s_lshl_b32 s12, s4, 13
  s_lshl_b32 s13, s5, 10
  s_add_u32 s12, s12, s13
  s_add_u32 s12, s12, 0
  v_add_u32 v40, s12, v3
  s_cmp_lg_u32 s75, 0
  s_cbranch_scc1 L_st_9
  global_store_dwordx4 v40, v[4:7], s[14:15] sc1
  s_branch L_st_10
L_st_9:
  global_store_dwordx4 v40, v[4:7], s[14:15]
L_st_10:
L_nw0_6:
  s_nop 4
  s_lshl_b32 s12, s4, 13
  s_lshl_b32 s13, s3, 8
  s_add_u32 s12, s12, s13
  s_add_u32 s12, s12, 0
  v_add_u32 v4, s12, v1
  v_add_u32 v5, 0x1000, v4
L_poll_11:
  s_nop 4
  global_load_dwordx4 v[40:43], v4, s[14:15] sc1
  global_load_dwordx4 v[44:47], v5, s[14:15] sc1
  s_waitcnt vmcnt(0)
  v_max_u32 v7, v40, v41
  v_max3_u32 v7, v7, v42, v43
  v_max3_u32 v7, v7, v44, v45
  v_max3_u32 v7, v7, v46, v47
  v_cmp_eq_u32 vcc, -1, v7
  s_sub_u32 s11, s11, 1
  s_cbranch_scc1 L_end
  s_cbranch_vccnz L_poll_11
  v_max_f32 v48, v42, v46
  v_mov_b32 v49, v48
  s_nop 1
  v_permlane16_swap_b32 v49, v48
  v_max_f32 v48, v48, v49
  v_mov_b32 v49, v48
  s_nop 1
  v_permlane32_swap_b32 v49, v48
  v_max_f32 v48, v48, v49
  v_sub_f32 v42, v42, v48
  v_sub_f32 v46, v46, v48
  v_mul_f32 v42, s8, v42
  v_mul_f32 v46, s8, v46
  v_exp_f32 v42, v42
  v_exp_f32 v46, v46
  v_mul_f32 v40, v40, v42
  v_mul_f32 v41, v41, v42
  v_mul_f32 v43, v43, v42
  v_fmac_f32 v40, v44, v46
  v_fmac_f32 v41, v45, v46
  v_fmac_f32 v43, v47, v46
  v_mov_b32 v45, v40
  v_mov_b32 v46, v41
  v_mov_b32 v47, v43
  v_permlane16_swap_b32 v45, v40
  v_permlane16_swap_b32 v46, v41
  v_permlane16_swap_b32 v47, v43
  v_add_f32 v40, v40, v45
  v_add_f32 v41, v41, v46
  v_add_f32 v43, v43, v47
  v_mov_b32 v45, v40
  v_mov_b32 v46, v41
  v_mov_b32 v47, v43
  v_permlane32_swap_b32 v45, v40
  v_permlane32_swap_b32 v46, v41
  v_permlane32_swap_b32 v47, v43
  v_add_f32 v40, v40, v45
  v_add_f32 v41, v41, v46
  v_add_f32 v43, v43, v47
  v_rcp_f32 v44, v43
  v_lshrrev_b32 v51, 3, v0
  v_and_b32 v51, 1, v51
  v_mul_f32 v45, v40, v44
  v_mul_f32 v46, v41, v44
  v_lshlrev_b32 v51, 4, v51
  v_fma_f32 v40, -v45, v43, v40
  v_fma_f32 v41, -v46, v43, v41
  v_fmac_f32 v45, v40, v44
  v_fmac_f32 v46, v41, v44
  v_cvt_pk_bf16_f32 v48, v45, v46
  v_mov_b32 v40, 0
  v_mov_b32 v41, 0
  v_mov_b32 v42, 0
  v_mov_b32 v43, 0
  v_mov_b32 v44, 0
  v_mov_b32 v45, 0
  v_mov_b32 v46, 0
  v_mov_b32 v47, 0
  v_mov_b32_dpp v52, v48 row_newbcast:0 row_mask:0x1 bank_mask:0xf
  v_mov_b32_dpp v52, v48 row_newbcast:1 row_mask:0x2 bank_mask:0xf
  v_mov_b32_dpp v52, v48 row_newbcast:2 row_mask:0x4 bank_mask:0xf
  v_mov_b32_dpp v52, v48 row_newbcast:3 row_mask:0x8 bank_mask:0xf
  v_mov_b32_dpp v53, v48 row_newbcast:4 row_mask:0x1 bank_mask:0xf
  v_mov_b32_dpp v53, v48 row_newbcast:5 row_mask:0x2 bank_mask:0xf
  v_mov_b32_dpp v53, v48 row_newbcast:6 row_mask:0x4 bank_mask:0xf
  v_mov_b32_dpp v53, v48 row_newbcast:7 row_mask:0x8 bank_mask:0xf
  v_mov_b32_dpp v54, v48 row_newbcast:8 row_mask:0x1 bank_mask:0xf
  v_mov_b32_dpp v54, v48 row_newbcast:9 row_mask:0x2 bank_mask:0xf
  v_mov_b32_dpp v54, v48 row_newbcast:10 row_mask:0x4 bank_mask:0xf
  v_mov_b32_dpp v54, v48 row_newbcast:11 row_mask:0x8 bank_mask:0xf
  v_mov_b32_dpp v55, v48 row_newbcast:12 row_mask:0x1 bank_mask:0xf
  v_mov_b32_dpp v55, v48 row_newbcast:13 row_mask:0x2 bank_mask:0xf
  v_mov_b32_dpp v55, v48 row_newbcast:14 row_mask:0x4 bank_mask:0xf
  v_mov_b32_dpp v55, v48 row_newbcast:15 row_mask:0x8 bank_mask:0xf
  v_lshrrev_b32 v52, v51, v52
  v_lshrrev_b32 v53, v51, v53
  v_lshrrev_b32 v54, v51, v54
  v_lshrrev_b32 v55, v51, v55
  v_lshlrev_b32 v49, 16, v52
  v_and_b32 v52, 0xffff, v52
  v_dot2c_f32_bf16 v40, v8, v52
  v_dot2c_f32_bf16 v41, v8, v49
  v_dot2c_f32_bf16 v42, v9, v52
  v_dot2c_f32_bf16 v43, v9, v49
  v_dot2c_f32_bf16 v44, v10, v52
  v_dot2c_f32_bf16 v45, v10, v49
  v_dot2c_f32_bf16 v46, v11, v52
  v_dot2c_f32_bf16 v47, v11, v49
  v_lshlrev_b32 v50, 16, v53
  v_and_b32 v53, 0xffff, v53
  v_dot2c_f32_bf16 v40, v12, v53
  v_dot2c_f32_bf16 v41, v12, v50
  v_dot2c_f32_bf16 v42, v13, v53
  v_dot2c_f32_bf16 v43, v13, v50
  v_dot2c_f32_bf16 v44, v14, v53
  v_dot2c_f32_bf16 v45, v14, v50
  v_dot2c_f32_bf16 v46, v15, v53
  v_dot2c_f32_bf16 v47, v15, v50
  v_lshlrev_b32 v49, 16, v54
  v_and_b32 v54, 0xffff, v54
  v_dot2c_f32_bf16 v40, v16, v54
  v_dot2c_f32_bf16 v41, v16, v49
  v_dot2c_f32_bf16 v42, v17, v54
  v_dot2c_f32_bf16 v43, v17, v49
  v_dot2c_f32_bf16 v44, v18, v54
  v_dot2c_f32_bf16 v45, v18, v49
  v_dot2c_f32_bf16 v46, v19, v54
  v_dot2c_f32_bf16 v47, v19, v49
  v_lshlrev_b32 v50, 16, v55
  v_and_b32 v55, 0xffff, v55
  v_dot2c_f32_bf16 v40, v20, v55
  v_dot2c_f32_bf16 v41, v20, v50
  v_dot2c_f32_bf16 v42, v21, v55
  v_dot2c_f32_bf16 v43, v21, v50
  v_dot2c_f32_bf16 v44, v22, v55
  v_dot2c_f32_bf16 v45, v22, v50
  v_dot2c_f32_bf16 v46, v23, v55
  v_dot2c_f32_bf16 v47, v23, v50
  v_and_b32 v4, 7, v0
  v_lshlrev_b32 v4, 12, v4
  v_lshrrev_b32 v5, 5, v0
  v_lshl_add_u32 v4, v5, 4, v4
  s_lshl_b32 s12, s5, 15
  s_lshl_b32 s13, s4, 7
  s_add_u32 s12, s12, s13
  s_lshl_b32 s13, s3, 5
  s_add_u32 s12, s12, s13
  s_add_u32 s12, s12, 262144
  v_add_u32 v4, s12, v4
  v_permlane32_swap_b32 v40, v44
  v_permlane32_swap_b32 v41, v45
  v_permlane32_swap_b32 v42, v46
  v_permlane32_swap_b32 v43, v47
  v_add_f32 v40, v40, v44
  v_add_f32 v41, v41, v45
  v_add_f32 v42, v42, v46
  v_add_f32 v43, v43, v47
  v_mov_b32 v44, v40
  v_mov_b32 v45, v41
  v_mov_b32 v46, v42
  v_mov_b32 v47, v43
  v_permlane16_swap_b32 v44, v40
  v_permlane16_swap_b32 v45, v41
  v_permlane16_swap_b32 v46, v42
  v_permlane16_swap_b32 v47, v43
  v_add_f32 v40, v40, v44
  v_add_f32 v41, v41, v45
  v_add_f32 v42, v42, v46
  v_add_f32 v43, v43, v47
  v_add_f32_dpp v40, v40, v40 row_ror:8 row_mask:0xf bank_mask:0xf
  v_add_f32_dpp v41, v41, v41 row_ror:8 row_mask:0xf bank_mask:0xf
  v_add_f32_dpp v42, v42, v42 row_ror:8 row_mask:0xf bank_mask:0xf
  v_add_f32_dpp v43, v43, v43 row_ror:8 row_mask:0xf bank_mask:0xf
  v_min_u32 v40, -2, v40
  v_min_u32 v41, -2, v41
  v_min_u32 v42, -2, v42
  v_min_u32 v43, -2, v43
  s_mov_b32 exec_lo, 0xff
  s_mov_b32 exec_hi, 0xff
  global_store_dwordx4 v4, v[40:43], s[14:15] sc1
  s_mov_b64 exec, -1
  s_cmp_ge_u32 s2, 192
  s_cbranch_scc1 L_dcu_12
  s_cmp_lg_u32 s10, 0
  s_cbranch_scc1 L_nowq_15
  v_and_b32 v4, 31, v0
  v_lshlrev_b32 v4, 13, v4
  v_lshrrev_b32 v5, 5, v0
  v_lshl_add_u32 v4, v5, 4, v4
  s_lshl_b32 s12, s4, 8
  s_lshl_b32 s13, s5, 5
  s_add_u32 s12, s12, s13
  s_lshl_b32 s13, s3, 20
  s_add_u32 s12, s12, s13
  v_add_u32 v4, s12, v4
  global_load_dwordx4 v[24:27], v4, s[22:23]
  v_add_u32 v4, 0x40000, v4
  global_load_dwordx4 v[28:31], v4, s[22:23]
  v_add_u32 v4, 0x40000, v4
  global_load_dwordx4 v[32:35], v4, s[22:23]
  v_add_u32 v4, 0x40000, v4
  global_load_dwordx4 v[36:39], v4, s[22:23]
L_nowq_15:
  s_nop 4
  s_cmp_ge_u32 s48, 172
  s_cbranch_scc1 L_other_14
  s_cmp_lg_u32 s3, 0
  s_cbranch_scc1 L_agskip_16
  s_and_b32 s12, s2, 7
  s_lshl_b32 s12, s12, 10
  s_add_u32 s12, s12, 557056
  v_add_u32 v4, s12, v3
L_poll_17:
  s_nop 4
  global_load_dwordx4 v[52:55], v4, s[14:15] offset:0 sc1
  s_waitcnt vmcnt(0)
  v_max_u32 v7, v52, v53
  v_max3_u32 v7, v7, v54, v55
  v_cmp_eq_u32 vcc, -1, v7
  s_sub_u32 s11, s11, 1
  s_cbranch_scc1 L_end
  s_cbranch_vccnz L_poll_17
  v_lshlrev_b32 v40, 16, v52
  v_and_b32 v41, 0xffff0000, v52
  v_lshlrev_b32 v42, 16, v53
  v_and_b32 v43, 0xffff0000, v53
  v_lshlrev_b32 v44, 16, v54
  v_and_b32 v45, 0xffff0000, v54
  v_lshlrev_b32 v46, 16, v55
  v_and_b32 v47, 0xffff0000, v55
  v_add_f32 v4, v40, v41
  v_add_f32 v5, v42, v43
  v_add_f32 v6, v44, v45
  v_add_f32 v48, v46, v47
  v_add_f32 v4, v4, v5
  v_add_f32 v6, v6, v48
  v_add_f32 v4, v4, v6
  s_nop 1
  v_add_f32_dpp v4, v4, v4 quad_perm:[1,0,3,2] row_mask:0xf bank_mask:0xf
  s_nop 1
  v_add_f32_dpp v4, v4, v4 quad_perm:[2,3,0,1] row_mask:0xf bank_mask:0xf
  s_nop 1
  v_add_f32_dpp v4, v4, v4 row_half_mirror row_mask:0xf bank_mask:0xf
  s_nop 1
  v_add_f32_dpp v4, v4, v4 row_mirror row_mask:0xf bank_mask:0xf
  v_mov_b32 v5, v4
  s_nop 1
  v_permlane16_swap_b32 v5, v4
  v_add_f32 v4, v4, v5
  v_mov_b32 v5, v4
  s_nop 1
  v_permlane32_swap_b32 v5, v4
  v_add_f32 v4, v4, v5
  v_mul_f32 v4, 0x3b000000, v4
  v_sub_f32 v48, v40, v4
  v_sub_f32 v49, v41, v4
  v_sub_f32 v50, v42, v4
  v_sub_f32 v51, v43, v4
  v_sub_f32 v16, v44, v4
  v_sub_f32 v17, v45, v4
  v_sub_f32 v18, v46, v4
  v_sub_f32 v19, v47, v4
  v_mul_f32 v6, v48, v48
  v_mul_f32 v5, v49, v49
  v_fmac_f32 v6, v50, v50
  v_fmac_f32 v5, v51, v51
  v_fmac_f32 v6, v16, v16
  v_fmac_f32 v5, v17, v17
  v_fmac_f32 v6, v18, v18
  v_fmac_f32 v5, v19, v19
  v_add_f32 v6, v6, v5
  v_cvt_pk_bf16_f32 v4, v4, v4
  v_and_b32 v4, 0xffff0000, v4
  v_add_f32_dpp v6, v6, v6 quad_perm:[1,0,3,2] row_mask:0xf bank_mask:0xf
  s_nop 1
  v_add_f32_dpp v6, v6, v6 quad_perm:[2,3,0,1] row_mask:0xf bank_mask:0xf
  s_nop 1
  v_add_f32_dpp v6, v6, v6 row_half_mirror row_mask:0xf bank_mask:0xf
  s_nop 1
  v_add_f32_dpp v6, v6, v6 row_mirror row_mask:0xf bank_mask:0xf
  v_mov_b32 v5, v6
  s_nop 1
  v_permlane16_swap_b32 v5, v6
  v_add_f32 v6, v6, v5
  v_mov_b32 v5, v6
  s_nop 1
  v_permlane32_swap_b32 v5, v6
  v_add_f32 v6, v6, v5
  v_sub_f32 v48, v40, v4
  v_sub_f32 v49, v41, v4
  v_sub_f32 v50, v42, v4
  v_sub_f32 v51, v43, v4
  v_sub_f32 v16, v44, v4
  v_sub_f32 v17, v45, v4
  v_sub_f32 v18, v46, v4
  v_sub_f32 v19, v47, v4
  v_mul_f32 v6, 0x3b000000, v6
  v_cvt_pk_bf16_f32 v6, v6, v6
  v_and_b32 v6, 0xffff0000, v6
  v_add_f32 v6, 0x3727c5ac, v6
  v_cvt_pk_bf16_f32 v6, v6, v6
  v_and_b32 v6, 0xffff0000, v6
  v_sqrt_f32 v6, v6
  v_cvt_pk_bf16_f32 v40, v48, v49
  v_cvt_pk_bf16_f32 v42, v50, v51
  v_cvt_pk_bf16_f32 v44, v16, v17
  v_cvt_pk_bf16_f32 v46, v18, v19
  v_cvt_pk_bf16_f32 v6, v6, v6
  v_and_b32 v6, 0xffff0000, v6
  v_rcp_f32 v5, v6
  v_and_b32 v41, 0xffff0000, v40
  v_lshlrev_b32 v40, 16, v40
  v_and_b32 v43, 0xffff0000, v42
  v_lshlrev_b32 v42, 16, v42
  v_and_b32 v45, 0xffff0000, v44
  v_lshlrev_b32 v44, 16, v44
  v_and_b32 v47, 0xffff0000, v46
  v_lshlrev_b32 v46, 16, v46
  v_mul_f32 v48, v40, v5
  v_mul_f32 v49, v41, v5
  v_mul_f32 v50, v42, v5
  v_mul_f32 v51, v43, v5
  v_mul_f32 v16, v44, v5
  v_mul_f32 v17, v45, v5
  v_mul_f32 v18, v46, v5
  v_mul_f32 v19, v47, v5
  v_fma_f32 v40, -v48, v6, v40
  v_fma_f32 v41, -v49, v6, v41
  v_fma_f32 v42, -v50, v6, v42
  v_fma_f32 v43, -v51, v6, v43
  v_fma_f32 v44, -v16, v6, v44
  v_fma_f32 v45, -v17, v6, v45
  v_fma_f32 v46, -v18, v6, v46
  v_fma_f32 v47, -v19, v6, v47
  v_fmac_f32 v48, v40, v5
  v_fmac_f32 v49, v41, v5
  v_fmac_f32 v50, v42, v5
  v_fmac_f32 v51, v43, v5
  v_fmac_f32 v16, v44, v5
  v_fmac_f32 v17, v45, v5
  v_fmac_f32 v18, v46, v5
  v_fmac_f32 v19, v47, v5
  v_cvt_pk_bf16_f32 v40, v48, v49
  v_cvt_pk_bf16_f32 v42, v50, v51
  v_cvt_pk_bf16_f32 v44, v16, v17
  v_cvt_pk_bf16_f32 v46, v18, v19
  v_lshlrev_b32 v48, 16, v40
  v_and_b32 v49, 0xffff0000, v40
  v_lshlrev_b32 v50, 16, v42
  v_and_b32 v51, 0xffff0000, v42
  v_lshlrev_b32 v16, 16, v44
  v_and_b32 v17, 0xffff0000, v44
  v_lshlrev_b32 v18, 16, v46
  v_and_b32 v19, 0xffff0000, v46
  v_lshlrev_b32 v4, 5, v0
  ds_write_b128 v4, v[48:51] offset:0
  ds_write_b128 v4, v[16:19] offset:16
  s_waitcnt lgkmcnt(0)
L_agskip_16:
  s_nop 4
  s_barrier
  v_lshlrev_b32 v4, 2, v0
  s_lshl_b32 s12, s3, 9
  v_add_u32 v4, s12, v4
  ds_read_b32 v48, v4 offset:0
  ds_read_b32 v49, v4 offset:256
  v_mov_b32 v40, 0
  v_mov_b32 v8, 0
  v_mov_b32 v41, 0
  v_mov_b32 v9, 0
  v_mov_b32 v42, 0
  v_mov_b32 v10, 0
  v_mov_b32 v43, 0
  v_mov_b32 v11, 0
  v_mov_b32 v44, 0
  v_mov_b32 v12, 0
  v_mov_b32 v45, 0
  v_mov_b32 v13, 0
  v_mov_b32 v46, 0
  v_mov_b32 v14, 0
  v_mov_b32 v47, 0
  v_mov_b32 v15, 0
  s_waitcnt lgkmcnt(0)
  v_lshrrev_b32 v50, 16, v48
  v_lshrrev_b32 v51, 16, v49
  v_dot2c_f32_bf16 v40, v232, v50
  v_dot2c_f32_bf16 v41, v232, v48
  v_dot2c_f32_bf16 v42, v233, v50
  v_dot2c_f32_bf16 v43, v233, v48
  v_dot2c_f32_bf16 v44, v234, v50
  v_dot2c_f32_bf16 v45, v234, v48
  v_dot2c_f32_bf16 v46, v235, v50
  v_dot2c_f32_bf16 v47, v235, v48
  v_dot2c_f32_bf16 v8, v240, v50
  v_dot2c_f32_bf16 v9, v240, v48
  v_dot2c_f32_bf16 v10, v241, v50
  v_dot2c_f32_bf16 v11, v241, v48
  v_dot2c_f32_bf16 v12, v242, v50
  v_dot2c_f32_bf16 v13, v242, v48
  v_dot2c_f32_bf16 v14, v243, v50
  v_dot2c_f32_bf16 v15, v243, v48
  v_dot2c_f32_bf16 v40, v236, v51
  v_dot2c_f32_bf16 v41, v236, v49
  v_dot2c_f32_bf16 v42, v237, v51
  v_dot2c_f32_bf16 v43, v237, v49
  v_dot2c_f32_bf16 v44, v238, v51
  v_dot2c_f32_bf16 v45, v238, v49
  v_dot2c_f32_bf16 v46, v239, v51
  v_dot2c_f32_bf16 v47, v239, v49
  v_dot2c_f32_bf16 v8, v244, v51
  v_dot2c_f32_bf16 v9, v244, v49
  v_dot2c_f32_bf16 v10, v245, v51
  v_dot2c_f32_bf16 v11, v245, v49
  v_dot2c_f32_bf16 v12, v246, v51
  v_dot2c_f32_bf16 v13, v246, v49
  v_dot2c_f32_bf16 v14, v247, v51
  v_dot2c_f32_bf16 v15, v247, v49
  v_permlane32_swap_b32 v40, v44
  v_permlane32_swap_b32 v41, v45
  v_permlane32_swap_b32 v42, v46
  v_permlane32_swap_b32 v43, v47
  v_permlane32_swap_b32 v8, v12
  v_permlane32_swap_b32 v9, v13
  v_permlane32_swap_b32 v10, v14
  v_permlane32_swap_b32 v11, v15
  v_add_f32 v40, v40, v44
  v_add_f32 v41, v41, v45
  v_add_f32 v42, v42, v46
  v_add_f32 v43, v43, v47
  v_add_f32 v8, v8, v12
  v_add_f32 v9, v9, v13
  v_add_f32 v10, v10, v14
  v_add_f32 v11, v11, v15
  v_permlane16_swap_b32 v40, v42
  v_permlane16_swap_b32 v41, v43
  v_permlane16_swap_b32 v8, v10
  v_permlane16_swap_b32 v9, v11
  v_add_f32 v40, v40, v42
  v_add_f32 v41, v41, v43
  v_add_f32 v8, v8, v10
  v_add_f32 v9, v9, v11
  v_lshrrev_b32 v4, 3, v0
  v_lshlrev_b32 v4, 4, v4
  v_add_f32_dpp v52, v40, v40 row_ror:8 row_mask:0xf bank_mask:0x3
  v_add_f32_dpp v53, v8, v8 row_ror:8 row_mask:0xf bank_mask:0x3
  v_add_f32_dpp v52, v41, v41 row_ror:8 row_mask:0xf bank_mask:0xc
  v_add_f32_dpp v53, v9, v9 row_ror:8 row_mask:0xf bank_mask:0xc
  s_lshl_b32 s12, s3, 2
  v_add_u32 v4, s12, v4
  v_add_f32_dpp v52, v52, v52 row_half_mirror row_mask:0xf bank_mask:0xf
  v_add_f32_dpp v53, v53, v53 row_half_mirror row_mask:0xf bank_mask:0xf
  s_nop 0
  v_add_f32_dpp v52, v52, v52 quad_perm:[1,0,3,2] row_mask:0xf bank_mask:0xf
  v_add_f32_dpp v53, v53, v53 quad_perm:[1,0,3,2] row_mask:0xf bank_mask:0xf
  s_nop 0
  v_add_f32_dpp v52, v52, v52 quad_perm:[2,3,0,1] row_mask:0xf bank_mask:0xf
  v_add_f32_dpp v53, v53, v53 quad_perm:[2,3,0,1] row_mask:0xf bank_mask:0xf
  ds_write_b32 v4, v52 offset:5120
  ds_write_b32 v4, v53 offset:5248
  s_waitcnt lgkmcnt(0)
  s_barrier
  s_cmp_lg_u32 s3, 0
  s_cbranch_scc1 L_noh_18
  v_and_b32 v4, 3, v0
  v_lshlrev_b32 v4, 5, v4
  ds_read_b128 v[40:43], v4 offset:5120
  ds_read_b128 v[44:47], v4 offset:5136
  ds_read_b128 v[48:51], v4 offset:5248
  ds_read_b128 v[52:55], v4 offset:5264
  v_lshlrev_b32 v4, 12, v0
  s_lshl_b32 s12, s48, 4
  s_add_u32 s12, s12, 524288
  v_add_u32 v4, s12, v4
  s_waitcnt lgkmcnt(0)
  v_add_f32 v40, v40, v41
  v_add_f32 v42, v42, v43
  v_add_f32 v44, v44, v45
  v_add_f32 v46, v46, v47
  v_add_f32 v48, v48, v49
  v_add_f32 v50, v50, v51
  v_add_f32 v52, v52, v53
  v_add_f32 v54, v54, v55
  v_add_f32 v40, v40, v42
  v_add_f32 v44, v44, v46
  v_add_f32 v48, v48, v50
  v_add_f32 v52, v52, v54
  v_cvt_pk_bf16_f32 v41, v40, v44
  v_cvt_pk_bf16_f32 v42, v48, v52
  v_lshlrev_b32 v40, 16, v41
  v_and_b32 v44, 0xffff0000, v41
  v_lshlrev_b32 v48, 16, v42
  v_and_b32 v52, 0xffff0000, v42
  v_mul_f32 v40, s8, v40
  v_mul_f32 v44, s8, v44
  v_exp_f32 v40, -v40
  v_exp_f32 v44, -v44
  v_add_f32 v40, 1.0, v40
  v_add_f32 v44, 1.0, v44
  v_rcp_f32 v40, v40
  v_rcp_f32 v44, v44
  s_nop 0
  v_cvt_pk_bf16_f32 v41, v40, v44
  v_lshlrev_b32 v40, 16, v41
  v_and_b32 v44, 0xffff0000, v41
  v_mul_f32 v40, v40, v48
  v_mul_f32 v44, v44, v52
  v_cvt_pk_bf16_f32 v48, v40, v44
  v_min_u32 v48, -2, v48
  s_nop 1
  v_mov_b32_dpp v40, v48 quad_perm:[0,0,0,0] row_mask:0xf bank_mask:0xf
  v_mov_b32_dpp v41, v48 quad_perm:[1,1,1,1] row_mask:0xf bank_mask:0xf
  v_mov_b32_dpp v42, v48 quad_perm:[2,2,2,2] row_mask:0xf bank_mask:0xf
  v_mov_b32_dpp v43, v48 quad_perm:[3,3,3,3] row_mask:0xf bank_mask:0xf
  s_mov_b64 exec, 0xff
  global_store_dwordx4 v4, v[40:43], s[14:15] sc1
  s_mov_b64 exec, -1
L_noh_18:
  s_nop 4
L_other_14:
  s_nop 4
  s_cmp_lg_u32 s10, 0
  s_cbranch_scc1 L_end
  s_branch L_toq_13
L_dcu_12:
  s_nop 4
  s_cmp_lg_u32 s3, 0
  s_cbranch_scc1 L_nocons_21
  s_lshl_b32 s12, s50, 4
  v_mov_b32 v4, s12
  s_cmp_lg_u32 s10, 0
  s_cbranch_scc1 L_res_19
  global_load_dwordx4 v[20:23], v4, s[16:17]
  s_branch L_res2_20
L_res_19:
  s_nop 4
  v_add_u32 v4, 565248, v4
  global_load_dwordx4 v[20:23], v4, s[38:39] sc1
L_res2_20:
  s_nop 4
  s_lshl_b32 s12, s50, 12
  s_add_u32 s12, s12, 262144
  v_add_u32 v4, s12, v3
L_poll_22:
  s_nop 4
  global_load_dwordx4 v[40:43], v4, s[14:15] offset:0 sc1
  global_load_dwordx4 v[44:47], v4, s[14:15] offset:1024 sc1
  global_load_dwordx4 v[48:51], v4, s[14:15] offset:2048 sc1
  global_load_dwordx4 v[52:55], v4, s[14:15] offset:3072 sc1
  s_waitcnt vmcnt(0)
  v_max_u32 v7, v40, v41
  v_max3_u32 v7, v7, v42, v43
  v_max3_u32 v7, v7, v44, v45
  v_max3_u32 v7, v7, v46, v47
  v_max3_u32 v7, v7, v48, v49
  v_max3_u32 v7, v7, v50, v51
  v_max3_u32 v7, v7, v52, v53
  v_max3_u32 v7, v7, v54, v55
  v_cmp_eq_u32 vcc, -1, v7
  s_sub_u32 s11, s11, 1
  s_cbranch_scc1 L_end
  s_cbranch_vccnz L_poll_22
  v_add_f32 v40, v40, v44
  v_add_f32 v48, v48, v52
  v_add_f32 v41, v41, v45
  v_add_f32 v49, v49, v53
  v_add_f32 v42, v42, v46
  v_add_f32 v50, v50, v54
  v_add_f32 v43, v43, v47
  v_add_f32 v51, v51, v55
  v_add_f32 v40, v40, v48
  v_add_f32 v41, v41, v49
  v_add_f32 v42, v42, v50
  v_add_f32 v43, v43, v51
  v_add_f32_dpp v40, v40, v40 row_ror:8 row_mask:0xf bank_mask:0xf
  v_add_f32_dpp v41, v41, v41 row_ror:8 row_mask:0xf bank_mask:0xf
  v_add_f32_dpp v42, v42, v42 row_ror:8 row_mask:0xf bank_mask:0xf
  v_add_f32_dpp v43, v43, v43 row_ror:8 row_mask:0xf bank_mask:0xf
  v_add_f32_dpp v40, v40, v40 row_ror:4 row_mask:0xf bank_mask:0xf
  v_add_f32_dpp v41, v41, v41 row_ror:4 row_mask:0xf bank_mask:0xf
  v_add_f32_dpp v42, v42, v42 row_ror:4 row_mask:0xf bank_mask:0xf
  v_add_f32_dpp v43, v43, v43 row_ror:4 row_mask:0xf bank_mask:0xf
  v_add_f32_dpp v40, v40, v40 row_ror:2 row_mask:0xf bank_mask:0xf
  v_add_f32_dpp v41, v41, v41 row_ror:2 row_mask:0xf bank_mask:0xf
  v_add_f32_dpp v42, v42, v42 row_ror:2 row_mask:0xf bank_mask:0xf
  v_add_f32_dpp v43, v43, v43 row_ror:2 row_mask:0xf bank_mask:0xf
  v_mov_b32 v44, v40
  v_mov_b32 v45, v41
  v_mov_b32 v46, v42
  v_mov_b32 v47, v43
  v_permlane16_swap_b32 v44, v40
  v_permlane16_swap_b32 v45, v41
  v_permlane16_swap_b32 v46, v42
  v_permlane16_swap_b32 v47, v43
  v_add_f32 v40, v40, v44
  v_add_f32 v41, v41, v45
  v_add_f32 v42, v42, v46
  v_add_f32 v43, v43, v47
  v_mov_b32 v44, v40
  v_mov_b32 v45, v41
  v_mov_b32 v46, v42
  v_mov_b32 v47, v43
  v_permlane32_swap_b32 v44, v40
  v_permlane32_swap_b32 v45, v41
  v_permlane32_swap_b32 v46, v42
  v_permlane32_swap_b32 v47, v43
  v_add_f32 v40, v40, v44
  v_add_f32 v41, v41, v45
  v_add_f32 v42, v42, v46
  v_add_f32 v43, v43, v47
  v_mov_b32_dpp v44, v40 quad_perm:[1,1,1,1] row_mask:0xf bank_mask:0xf
  v_mov_b32_dpp v45, v41 quad_perm:[1,1,1,1] row_mask:0xf bank_mask:0xf
  v_mov_b32_dpp v46, v42 quad_perm:[1,1,1,1] row_mask:0xf bank_mask:0xf
  v_mov_b32_dpp v47, v43 quad_perm:[1,1,1,1] row_mask:0xf bank_mask:0xf
  v_mov_b32_dpp v40, v40 quad_perm:[0,0,0,0] row_mask:0xf bank_mask:0xf
  v_mov_b32_dpp v41, v41 quad_perm:[0,0,0,0] row_mask:0xf bank_mask:0xf
  v_mov_b32_dpp v42, v42 quad_perm:[0,0,0,0] row_mask:0xf bank_mask:0xf
  v_mov_b32_dpp v43, v43 quad_perm:[0,0,0,0] row_mask:0xf bank_mask:0xf
  v_cvt_pk_bf16_f32 v48, v40, v41
  v_cvt_pk_bf16_f32 v49, v42, v43
  v_cvt_pk_bf16_f32 v50, v44, v45
  v_cvt_pk_bf16_f32 v51, v46, v47
  v_lshlrev_b32 v40, 16, v48
  v_and_b32 v41, 0xffff0000, v48
  v_lshlrev_b32 v42, 16, v49
  v_and_b32 v43, 0xffff0000, v49
  v_lshlrev_b32 v44, 16, v50
  v_and_b32 v45, 0xffff0000, v50
  v_lshlrev_b32 v46, 16, v51
  v_and_b32 v47, 0xffff0000, v51
  v_lshlrev_b32 v48, 16, v20
  v_and_b32 v49, 0xffff0000, v20
  v_add_f32 v40, v40, v48
  v_add_f32 v41, v41, v49
  v_lshlrev_b32 v50, 16, v21
  v_and_b32 v51, 0xffff0000, v21
  v_add_f32 v42, v42, v50
  v_add_f32 v43, v43, v51
  v_lshlrev_b32 v48, 16, v22
  v_and_b32 v49, 0xffff0000, v22
  v_add_f32 v44, v44, v48
  v_add_f32 v45, v45, v49
  v_lshlrev_b32 v50, 16, v23
  v_and_b32 v51, 0xffff0000, v23
  v_add_f32 v46, v46, v50
  v_add_f32 v47, v47, v51
  v_cvt_pk_bf16_f32 v20, v40, v41
  v_cvt_pk_bf16_f32 v21, v42, v43
  v_cvt_pk_bf16_f32 v22, v44, v45
  v_cvt_pk_bf16_f32 v23, v46, v47
  v_lshlrev_b32 v4, 10, v0
  s_lshl_b32 s12, s50, 4
  s_add_u32 s12, s12, 557056
  v_add_u32 v4, s12, v4
  v_min_u32 v40, -2, v20
  v_min_u32 v41, -2, v21
  v_min_u32 v42, -2, v22
  v_min_u32 v43, -2, v23
  s_mov_b64 exec, 0xff
  global_store_dwordx4 v4, v[40:43], s[14:15] sc1
  s_mov_b64 exec, -1
L_nocons_21:
  s_nop 4
  s_cmp_lg_u32 s10, 0
  s_cbranch_scc1 L_nowq_23
  v_and_b32 v4, 31, v0
  v_lshlrev_b32 v4, 13, v4
  v_lshrrev_b32 v5, 5, v0
  v_lshl_add_u32 v4, v5, 4, v4
  s_lshl_b32 s12, s4, 8
  s_lshl_b32 s13, s5, 5
  s_add_u32 s12, s12, s13
  s_lshl_b32 s13, s3, 20
  s_add_u32 s12, s12, s13
  v_add_u32 v4, s12, v4
  global_load_dwordx4 v[24:27], v4, s[22:23]
  v_add_u32 v4, 0x40000, v4
  global_load_dwordx4 v[28:31], v4, s[22:23]
  v_add_u32 v4, 0x40000, v4
  global_load_dwordx4 v[32:35], v4, s[22:23]
  v_add_u32 v4, 0x40000, v4
  global_load_dwordx4 v[36:39], v4, s[22:23]
L_nowq_23:
  s_nop 4
  s_and_b32 s12, s2, 7
  s_lshl_b32 s12, s12, 12
  s_mul_i32 s13, s3, 688
  s_add_u32 s12, s12, s13
  s_add_u32 s12, s12, 524288
  v_lshlrev_b32 v4, 2, v0
  v_add_u32 v4, s12, v4
  v_mov_b32 v50, 0
  v_mov_b32 v40, 0
  v_mov_b32 v41, 0
  v_mov_b32 v42, 0
  v_mov_b32 v43, 0
  v_mov_b32 v44, 0
  v_mov_b32 v45, 0
  v_mov_b32 v46, 0
  v_mov_b32 v47, 0
L_poll_24:
  s_nop 4
  global_load_dword v48, v4, s[14:15] sc1
  global_load_dword v49, v4, s[14:15] offset:256 sc1
  s_mov_b32 exec_hi, 0xfff
  global_load_dword v50, v4, s[14:15] offset:512 sc1
  s_mov_b64 exec, -1
  s_waitcnt vmcnt(0)
  v_max3_u32 v7, v48, v49, v50
  v_cmp_eq_u32 vcc, -1, v7
  s_sub_u32 s11, s11, 1
  s_cbranch_scc1 L_end
  s_cbranch_vccnz L_poll_24
  v_and_b32 v52, 0xffff, v48
  v_lshlrev_b32 v53, 16, v48
  v_lshrrev_b32 v54, 16, v48
  v_and_b32 v55, 0xffff0000, v48
  v_dot2c_f32_bf16 v40, v232, v52
  v_dot2c_f32_bf16 v41, v232, v53
  v_dot2c_f32_bf16 v42, v233, v52
  v_dot2c_f32_bf16 v43, v233, v53
  v_dot2c_f32_bf16 v44, v234, v52
  v_dot2c_f32_bf16 v45, v234, v53
  v_dot2c_f32_bf16 v46, v235, v52
  v_dot2c_f32_bf16 v47, v235, v53
  v_dot2c_f32_bf16 v40, v236, v54
  v_dot2c_f32_bf16 v41, v236, v55
  v_dot2c_f32_bf16 v42, v237, v54
  v_dot2c_f32_bf16 v43, v237, v55
  v_dot2c_f32_bf16 v44, v238, v54
  v_dot2c_f32_bf16 v45, v238, v55
  v_dot2c_f32_bf16 v46, v239, v54
  v_dot2c_f32_bf16 v47, v239, v55
  v_and_b32 v52, 0xffff, v49
  v_lshlrev_b32 v53, 16, v49
  v_lshrrev_b32 v54, 16, v49
  v_and_b32 v55, 0xffff0000, v49
  v_dot2c_f32_bf16 v40, v240, v52
  v_dot2c_f32_bf16 v41, v240, v53
  v_dot2c_f32_bf16 v42, v241, v52
  v_dot2c_f32_bf16 v43, v241, v53
  v_dot2c_f32_bf16 v44, v242, v52
  v_dot2c_f32_bf16 v45, v242, v53
  v_dot2c_f32_bf16 v46, v243, v52
  v_dot2c_f32_bf16 v47, v243, v53
  v_dot2c_f32_bf16 v40, v244, v54
  v_dot2c_f32_bf16 v41, v244, v55
  v_dot2c_f32_bf16 v42, v245, v54
  v_dot2c_f32_bf16 v43, v245, v55
  v_dot2c_f32_bf16 v44, v246, v54
  v_dot2c_f32_bf16 v45, v246, v55
  v_dot2c_f32_bf16 v46, v247, v54
  v_dot2c_f32_bf16 v47, v247, v55
  v_and_b32 v52, 0xffff, v50
  v_lshlrev_b32 v53, 16, v50
  v_lshrrev_b32 v54, 16, v50
  v_and_b32 v55, 0xffff0000, v50
  v_dot2c_f32_bf16 v40, v248, v52
  v_dot2c_f32_bf16 v41, v248, v53
  v_dot2c_f32_bf16 v42, v249, v52
  v_dot2c_f32_bf16 v43, v249, v53
  v_dot2c_f32_bf16 v44, v250, v52
  v_dot2c_f32_bf16 v45, v250, v53
  v_dot2c_f32_bf16 v46, v251, v52
  v_dot2c_f32_bf16 v47, v251, v53
  v_dot2c_f32_bf16 v40, v252, v54
  v_dot2c_f32_bf16 v41, v252, v55
  v_dot2c_f32_bf16 v42, v253, v54
  v_dot2c_f32_bf16 v43, v253, v55
  v_dot2c_f32_bf16 v44, v254, v54
  v_dot2c_f32_bf16 v45, v254, v55
  v_dot2c_f32_bf16 v46, v255, v54
  v_dot2c_f32_bf16 v47, v255, v55
  v_permlane32_swap_b32 v40, v44
  v_permlane32_swap_b32 v41, v45
  v_permlane32_swap_b32 v42, v46
  v_permlane32_swap_b32 v43, v47
  v_add_f32 v40, v40, v44
  v_add_f32 v41, v41, v45
  v_add_f32 v42, v42, v46
  v_add_f32 v43, v43, v47
  s_nop 0
  v_permlane16_swap_b32 v40, v42
  v_permlane16_swap_b32 v41, v43
  v_add_f32 v40, v40, v42
  v_add_f32 v41, v41, v43
  v_lshrrev_b32 v6, 3, v0
  v_lshlrev_b32 v6, 2, v6
  v_add_f32_dpp v52, v40, v40 row_ror:8 row_mask:0xf bank_mask:0x3
  v_add_f32_dpp v52, v41, v41 row_ror:8 row_mask:0xf bank_mask:0xc
  s_lshl_b32 s12, s3, 5
  v_add_u32 v6, s12, v6
  v_add_f32_dpp v52, v52, v52 row_half_mirror row_mask:0xf bank_mask:0xf
  s_nop 1
  v_add_f32_dpp v52, v52, v52 quad_perm:[1,0,3,2] row_mask:0xf bank_mask:0xf
  s_nop 1
  v_add_f32_dpp v52, v52, v52 quad_perm:[2,3,0,1] row_mask:0xf bank_mask:0xf
  ds_write_b32 v6, v52 offset:3072
  s_waitcnt lgkmcnt(0)
  s_barrier
  s_cmp_lg_u32 s3, 0
  s_cbranch_scc1 L_nofin_25
  v_mov_b32 v4, 0
  ds_read_b128 v[40:43], v4 offset:3072
  ds_read_b128 v[44:47], v4 offset:3088
  ds_read_b128 v[48:51], v4 offset:3104
  ds_read_b128 v[52:55], v4 offset:3120
  ds_read_b128 v[8:11], v4 offset:3136
  ds_read_b128 v[12:15], v4 offset:3152
  ds_read_b128 v[16:19], v4 offset:3168
  s_waitcnt lgkmcnt(3)
  v_add_f32 v40, v40, v48
  v_add_f32 v41, v41, v49
  v_add_f32 v42, v42, v50
  v_add_f32 v43, v43, v51
  v_add_f32 v44, v44, v52
  v_add_f32 v45, v45, v53
  v_add_f32 v46, v46, v54
  v_add_f32 v47, v47, v55
  ds_read_b128 v[48:51], v4 offset:3184
  s_waitcnt lgkmcnt(1)
  v_add_f32 v40, v40, v8
  v_add_f32 v41, v41, v9
  v_add_f32 v42, v42, v10
  v_add_f32 v43, v43, v11
  v_add_f32 v44, v44, v12
  v_add_f32 v45, v45, v13
  v_add_f32 v46, v46, v14
  v_add_f32 v47, v47, v15
  v_add_f32 v40, v40, v16
  v_add_f32 v41, v41, v17
  v_add_f32 v42, v42, v18
  v_add_f32 v43, v43, v19
  s_waitcnt lgkmcnt(0)
  v_add_f32 v44, v44, v48
  v_add_f32 v45, v45, v49
  v_add_f32 v46, v46, v50
  v_add_f32 v47, v47, v51
  v_cvt_pk_bf16_f32 v48, v40, v41
  v_cvt_pk_bf16_f32 v49, v42, v43
  v_cvt_pk_bf16_f32 v50, v44, v45
  v_cvt_pk_bf16_f32 v51, v46, v47
  v_lshlrev_b32 v40, 16, v48
  v_and_b32 v41, 0xffff0000, v48
  v_lshlrev_b32 v42, 16, v49
  v_and_b32 v43, 0xffff0000, v49
  v_lshlrev_b32 v44, 16, v50
  v_and_b32 v45, 0xffff0000, v50
  v_lshlrev_b32 v46, 16, v51
  v_and_b32 v47, 0xffff0000, v51
  v_lshlrev_b32 v48, 16, v20
  v_and_b32 v49, 0xffff0000, v20
  v_add_f32 v40, v40, v48
  v_add_f32 v41, v41, v49
  v_lshlrev_b32 v50, 16, v21
  v_and_b32 v51, 0xffff0000, v21
  v_add_f32 v42, v42, v50
  v_add_f32 v43, v43, v51
  v_lshlrev_b32 v48, 16, v22
  v_and_b32 v49, 0xffff0000, v22
  v_add_f32 v44, v44, v48
  v_add_f32 v45, v45, v49
  v_lshlrev_b32 v50, 16, v23
  v_and_b32 v51, 0xffff0000, v23
  v_add_f32 v46, v46, v50
  v_add_f32 v47, v47, v51
  v_cvt_pk_bf16_f32 v20, v40, v41
  v_cvt_pk_bf16_f32 v21, v42, v43
  v_cvt_pk_bf16_f32 v22, v44, v45
  v_cvt_pk_bf16_f32 v23, v46, v47
  s_cmp_eq_u32 s10, 0
  s_cbranch_scc1 L_notfinal_26
  s_lshl_b32 s12, s50, 4
  v_mov_b32 v4, s12
  s_mov_b64 exec, 1
  global_store_dwordx4 v4, v[20:23], s[34:35]
  s_mov_b64 exec, -1
  s_branch L_end
L_notfinal_26:
  s_nop 4
  v_lshlrev_b32 v4, 10, v0
  s_lshl_b32 s12, s50, 4
  s_add_u32 s12, s12, 565248
  v_add_u32 v4, s12, v4
  v_min_u32 v40, -2, v20
  v_min_u32 v41, -2, v21
  v_min_u32 v42, -2, v22
  v_min_u32 v43, -2, v23
  s_mov_b64 exec, 0xff
  global_store_dwordx4 v4, v[40:43], s[14:15] sc1
  s_mov_b64 exec, -1
L_nofin_25:
  s_nop 4
  s_cmp_lg_u32 s10, 0
  s_cbranch_scc1 L_end
L_toq_13:
  s_nop 4
  s_cmp_lg_u32 s3, 0
  s_cbranch_scc1 L_agskip_27
  s_and_b32 s12, s2, 7
  s_lshl_b32 s12, s12, 10
  s_add_u32 s12, s12, 565248
  v_add_u32 v4, s12, v3
L_poll_28:
  s_nop 4
  global_load_dwordx4 v[52:55], v4, s[14:15] offset:0 sc1
  s_waitcnt vmcnt(0)
  v_max_u32 v7, v52, v53
  v_max3_u32 v7, v7, v54, v55
  v_cmp_eq_u32 vcc, -1, v7
  s_sub_u32 s11, s11, 1
  s_cbranch_scc1 L_end
  s_cbranch_vccnz L_poll_28
  v_lshlrev_b32 v40, 16, v52
  v_and_b32 v41, 0xffff0000, v52
  v_lshlrev_b32 v42, 16, v53
  v_and_b32 v43, 0xffff0000, v53
  v_lshlrev_b32 v44, 16, v54
  v_and_b32 v45, 0xffff0000, v54
  v_lshlrev_b32 v46, 16, v55
  v_and_b32 v47, 0xffff0000, v55
  v_add_f32 v4, v40, v41
  v_add_f32 v5, v42, v43
  v_add_f32 v6, v44, v45
  v_add_f32 v48, v46, v47
  v_add_f32 v4, v4, v5
  v_add_f32 v6, v6, v48
  v_add_f32 v4, v4, v6
  s_nop 1
  v_add_f32_dpp v4, v4, v4 quad_perm:[1,0,3,2] row_mask:0xf bank_mask:0xf
  s_nop 1
  v_add_f32_dpp v4, v4, v4 quad_perm:[2,3,0,1] row_mask:0xf bank_mask:0xf
  s_nop 1
  v_add_f32_dpp v4, v4, v4 row_half_mirror row_mask:0xf bank_mask:0xf
  s_nop 1
  v_add_f32_dpp v4, v4, v4 row_mirror row_mask:0xf bank_mask:0xf
  v_mov_b32 v5, v4
  s_nop 1
  v_permlane16_swap_b32 v5, v4
  v_add_f32 v4, v4, v5
  v_mov_b32 v5, v4
  s_nop 1
  v_permlane32_swap_b32 v5, v4
  v_add_f32 v4, v4, v5
  v_mul_f32 v4, 0x3b000000, v4
  v_sub_f32 v48, v40, v4
  v_sub_f32 v49, v41, v4
  v_sub_f32 v50, v42, v4
  v_sub_f32 v51, v43, v4
  v_sub_f32 v16, v44, v4
  v_sub_f32 v17, v45, v4
  v_sub_f32 v18, v46, v4
  v_sub_f32 v19, v47, v4
  v_mul_f32 v6, v48, v48
  v_mul_f32 v5, v49, v49
  v_fmac_f32 v6, v50, v50
  v_fmac_f32 v5, v51, v51
  v_fmac_f32 v6, v16, v16
  v_fmac_f32 v5, v17, v17
  v_fmac_f32 v6, v18, v18
  v_fmac_f32 v5, v19, v19
  v_add_f32 v6, v6, v5
  v_cvt_pk_bf16_f32 v4, v4, v4
  v_and_b32 v4, 0xffff0000, v4
  v_add_f32_dpp v6, v6, v6 quad_perm:[1,0,3,2] row_mask:0xf bank_mask:0xf
  s_nop 1
  v_add_f32_dpp v6, v6, v6 quad_perm:[2,3,0,1] row_mask:0xf bank_mask:0xf
  s_nop 1
  v_add_f32_dpp v6, v6, v6 row_half_mirror row_mask:0xf bank_mask:0xf
  s_nop 1
  v_add_f32_dpp v6, v6, v6 row_mirror row_mask:0xf bank_mask:0xf
  v_mov_b32 v5, v6
  s_nop 1
  v_permlane16_swap_b32 v5, v6
  v_add_f32 v6, v6, v5
  v_mov_b32 v5, v6
  s_nop 1
  v_permlane32_swap_b32 v5, v6
  v_add_f32 v6, v6, v5
  v_sub_f32 v48, v40, v4
  v_sub_f32 v49, v41, v4
  v_sub_f32 v50, v42, v4
  v_sub_f32 v51, v43, v4
  v_sub_f32 v16, v44, v4
  v_sub_f32 v17, v45, v4
  v_sub_f32 v18, v46, v4
  v_sub_f32 v19, v47, v4
  v_mul_f32 v6, 0x3b000000, v6
  v_cvt_pk_bf16_f32 v6, v6, v6
  v_and_b32 v6, 0xffff0000, v6
  v_add_f32 v6, 0x3727c5ac, v6
  v_cvt_pk_bf16_f32 v6, v6, v6
  v_and_b32 v6, 0xffff0000, v6
  v_sqrt_f32 v6, v6
  v_cvt_pk_bf16_f32 v40, v48, v49
  v_cvt_pk_bf16_f32 v42, v50, v51
  v_cvt_pk_bf16_f32 v44, v16, v17
  v_cvt_pk_bf16_f32 v46, v18, v19
  v_cvt_pk_bf16_f32 v6, v6, v6
  v_and_b32 v6, 0xffff0000, v6
  v_rcp_f32 v5, v6
  v_and_b32 v41, 0xffff0000, v40
  v_lshlrev_b32 v40, 16, v40
  v_and_b32 v43, 0xffff0000, v42
  v_lshlrev_b32 v42, 16, v42
  v_and_b32 v45, 0xffff0000, v44
  v_lshlrev_b32 v44, 16, v44
  v_and_b32 v47, 0xffff0000, v46
  v_lshlrev_b32 v46, 16, v46
  v_mul_f32 v48, v40, v5
  v_mul_f32 v49, v41, v5
  v_mul_f32 v50, v42, v5
  v_mul_f32 v51, v43, v5
  v_mul_f32 v16, v44, v5
  v_mul_f32 v17, v45, v5
  v_mul_f32 v18, v46, v5
  v_mul_f32 v19, v47, v5
  v_fma_f32 v40, -v48, v6, v40
  v_fma_f32 v41, -v49, v6, v41
  v_fma_f32 v42, -v50, v6, v42
  v_fma_f32 v43, -v51, v6, v43
  v_fma_f32 v44, -v16, v6, v44
  v_fma_f32 v45, -v17, v6, v45
  v_fma_f32 v46, -v18, v6, v46
  v_fma_f32 v47, -v19, v6, v47
  v_fmac_f32 v48, v40, v5
  v_fmac_f32 v49, v41, v5
  v_fmac_f32 v50, v42, v5
  v_fmac_f32 v51, v43, v5
  v_fmac_f32 v16, v44, v5
  v_fmac_f32 v17, v45, v5
  v_fmac_f32 v18, v46, v5
  v_fmac_f32 v19, v47, v5
  v_cvt_pk_bf16_f32 v40, v48, v49
  v_cvt_pk_bf16_f32 v42, v50, v51
  v_cvt_pk_bf16_f32 v44, v16, v17
  v_cvt_pk_bf16_f32 v46, v18, v19
  v_lshlrev_b32 v48, 16, v40
  v_and_b32 v49, 0xffff0000, v40
  v_lshlrev_b32 v50, 16, v42
  v_and_b32 v51, 0xffff0000, v42
  v_lshlrev_b32 v16, 16, v44
  v_and_b32 v17, 0xffff0000, v44
  v_lshlrev_b32 v18, 16, v46
  v_and_b32 v19, 0xffff0000, v46
  v_lshlrev_b32 v4, 5, v0
  ds_write_b128 v4, v[48:51] offset:0
  ds_write_b128 v4, v[16:19] offset:16
  s_waitcnt lgkmcnt(0)
L_agskip_27:
  s_nop 4
  s_barrier
  v_and_b32 v4, 31, v0
  v_lshlrev_b32 v4, 2, v4
  s_lshl_b32 s12, s3, 9
  v_add_u32 v4, s12, v4
  ds_read_b32 v48, v4 offset:0
  ds_read_b32 v49, v4 offset:128
  ds_read_b32 v50, v4 offset:256
  ds_read_b32 v51, v4 offset:384
  v_mov_b32 v40, 0
  v_mov_b32 v41, 0
  v_mov_b32 v42, 0
  v_mov_b32 v43, 0
  v_mov_b32 v44, 0
  v_mov_b32 v45, 0
  v_mov_b32 v46, 0
  v_mov_b32 v47, 0
  s_waitcnt vmcnt(0)
  s_waitcnt lgkmcnt(0)
  v_lshrrev_b32 v52, 16, v48
  v_lshrrev_b32 v53, 16, v49
  v_lshrrev_b32 v54, 16, v50
  v_lshrrev_b32 v55, 16, v51
  v_dot2c_f32_bf16 v40, v24, v52
  v_dot2c_f32_bf16 v41, v24, v48
  v_dot2c_f32_bf16 v42, v25, v52
  v_dot2c_f32_bf16 v43, v25, v48
  v_dot2c_f32_bf16 v44, v26, v52
  v_dot2c_f32_bf16 v45, v26, v48
  v_dot2c_f32_bf16 v46, v27, v52
  v_dot2c_f32_bf16 v47, v27, v48
  v_dot2c_f32_bf16 v40, v28, v53
  v_dot2c_f32_bf16 v41, v28, v49
  v_dot2c_f32_bf16 v42, v29, v53
  v_dot2c_f32_bf16 v43, v29, v49
  v_dot2c_f32_bf16 v44, v30, v53
  v_dot2c_f32_bf16 v45, v30, v49
  v_dot2c_f32_bf16 v46, v31, v53
  v_dot2c_f32_bf16 v47, v31, v49
  v_dot2c_f32_bf16 v40, v32, v54
  v_dot2c_f32_bf16 v41, v32, v50
  v_dot2c_f32_bf16 v42, v33, v54
  v_dot2c_f32_bf16 v43, v33, v50
  v_dot2c_f32_bf16 v44, v34, v54
  v_dot2c_f32_bf16 v45, v34, v50
  v_dot2c_f32_bf16 v46, v35, v54
  v_dot2c_f32_bf16 v47, v35, v50
  v_dot2c_f32_bf16 v40, v36, v55
  v_dot2c_f32_bf16 v41, v36, v51
  v_dot2c_f32_bf16 v42, v37, v55
  v_dot2c_f32_bf16 v43, v37, v51
  v_dot2c_f32_bf16 v44, v38, v55
  v_dot2c_f32_bf16 v45, v38, v51
  v_dot2c_f32_bf16 v46, v39, v55
  v_dot2c_f32_bf16 v47, v39, v51
  v_permlane16_swap_b32 v40, v44
  v_permlane16_swap_b32 v41, v45
  v_permlane16_swap_b32 v42, v46
  v_permlane16_swap_b32 v43, v47
  v_add_f32 v40, v40, v44
  v_add_f32 v41, v41, v45
  v_add_f32 v42, v42, v46
  v_add_f32 v43, v43, v47
  v_add_f32_dpp v44, v40, v40 row_ror:8 row_mask:0xf bank_mask:0x3
  v_add_f32_dpp v45, v41, v41 row_ror:8 row_mask:0xf bank_mask:0x3
  v_add_f32_dpp v44, v42, v42 row_ror:8 row_mask:0xf bank_mask:0xc
  v_add_f32_dpp v45, v43, v43 row_ror:8 row_mask:0xf bank_mask:0xc
  v_lshrrev_b32 v4, 2, v0
  v_add_f32_dpp v46, v44, v44 row_half_mirror row_mask:0xf bank_mask:0x5
  v_add_f32_dpp v46, v45, v45 row_half_mirror row_mask:0xf bank_mask:0xa
  v_lshlrev_b32 v4, 4, v4
  s_lshl_b32 s12, s3, 2
  v_add_f32_dpp v46, v46, v46 quad_perm:[1,0,3,2] row_mask:0xf bank_mask:0xf
  v_add_u32 v4, s12, v4
  s_nop 0
  v_add_f32_dpp v46, v46, v46 quad_perm:[2,3,0,1] row_mask:0xf bank_mask:0xf
  ds_write_b32 v4, v46 offset:7168
  s_waitcnt lgkmcnt(0)
  s_barrier
  s_cmp_lg_u32 s3, 0
  s_cbranch_scc1 L_nq_29
  v_and_b32 v4, 7, v0
  v_lshlrev_b32 v4, 5, v4
  ds_read_b128 v[40:43], v4 offset:7168
  ds_read_b128 v[44:47], v4 offset:7184
  v_lshlrev_b32 v4, 2, v0
  s_lshl_b32 s12, s4, 10
  s_lshl_b32 s13, s5, 7
  s_add_u32 s12, s12, s13
  s_add_u32 s12, s12, 589824
  v_add_u32 v4, s12, v4
  s_waitcnt lgkmcnt(0)
  v_add_f32 v40, v40, v41
  v_add_f32 v42, v42, v43
  v_add_f32 v44, v44, v45
  v_add_f32 v46, v46, v47
  v_add_f32 v40, v40, v42
  v_add_f32 v44, v44, v46
  v_cvt_pk_bf16_f32 v40, v40, v44
  v_min_u32 v40, -2, v40
  s_mov_b64 exec, 0xff
  s_cmp_lg_u32 s75, 0
  s_cbranch_scc1 L_st_30
  global_store_dword v4, v40, s[14:15] sc1
  s_branch L_st_31
L_st_30:
  global_store_dword v4, v40, s[14:15]
L_st_31:
  s_mov_b64 exec, -1
L_nq_29:
  s_nop 4
  v_lshrrev_b32 v4, 5, v0
  v_lshlrev_b32 v4, 7, v4
  v_bfe_u32 v5, v0, 4, 1
  v_lshl_add_u32 v4, v5, 4, v4
  s_lshl_b32 s12, s4, 10
  s_add_u32 s12, s12, 589824
  v_add_u32 v4, s12, v4
L_poll_32:
  s_nop 4
  global_load_dwordx4 v[8:11], v4, s[14:15] offset:0 sc1
  global_load_dwordx4 v[12:15], v4, s[14:15] offset:256 sc1
  global_load_dwordx4 v[16:19], v4, s[14:15] offset:512 sc1
  global_load_dwordx4 v[20:23], v4, s[14:15] offset:768 sc1
  s_waitcnt vmcnt(0)
  v_max_u32 v7, v8, v9
  v_max3_u32 v7, v7, v10, v11
  v_max3_u32 v7, v7, v12, v13
  v_max3_u32 v7, v7, v14, v15
  v_max3_u32 v7, v7, v16, v17
  v_max3_u32 v7, v7, v18, v19
  v_max3_u32 v7, v7, v20, v21
  v_max3_u32 v7, v7, v22, v23
  v_cmp_eq_u32 vcc, -1, v7
  s_sub_u32 s11, s11, 1
  s_cbranch_scc1 L_end
  s_cbranch_vccnz L_poll_32
  v_add_u32 v7, s49, v3
  v_lshrrev_b32 v6, 4, v0
  v_lshlrev_b32 v6, 4, v6
  s_lshl_b32 s12, s3, 11
  v_add_u32 v6, s12, v6
  v_and_b32 v4, 15, v0
  v_lshrrev_b32 v5, 4, v0
  v_xor_b32 v5, v5, v4
  v_lshlrev_b32 v5, 4, v5
  v_lshl_add_u32 v4, v4, 8, v5
  v_add_u32 v52, s49, v4
  v_xor_b32 v53, 64, v52
  v_xor_b32 v54, 128, v52
  v_xor_b32 v55, 192, v52
  v_mfma_f32_16x16x32_bf16 v[24:27], a[0:3], v[8:11], 0
  s_add_u32 s7, s6, 442368
  buffer_load_dwordx4 a[0:3], v1, s[44:47], s7 offen offset:0 nt
  v_mfma_f32_16x16x32_bf16 v[24:27], a[4:7], v[12:15], v[24:27]
  buffer_load_dwordx4 a[4:7], v1, s[44:47], s7 offen offset:256 nt
  v_mfma_f32_16x16x32_bf16 v[24:27], a[8:11], v[16:19], v[24:27]
  s_add_u32 s7, s6, 425984
  buffer_load_dwordx4 a[8:11], v1, s[44:47], s7 offen offset:0 nt
  v_mfma_f32_16x16x32_bf16 v[24:27], a[12:15], v[20:23], v[24:27]
  buffer_load_dwordx4 a[12:15], v1, s[44:47], s7 offen offset:256 nt
  v_mfma_f32_16x16x32_bf16 v[28:31], a[16:19], v[8:11], 0
  buffer_load_dwordx4 a[16:19], v1, s[44:47], s7 offen offset:512 nt
  v_mfma_f32_16x16x32_bf16 v[28:31], a[20:23], v[12:15], v[28:31]
  buffer_load_dwordx4 a[20:23], v1, s[44:47], s7 offen offset:768 nt
  v_mfma_f32_16x16x32_bf16 v[28:31], a[24:27], v[16:19], v[28:31]
  s_add_u32 s7, s6, 409600
  buffer_load_dwordx4 a[24:27], v1, s[44:47], s7 offen offset:0 nt
  v_mfma_f32_16x16x32_bf16 v[28:31], a[28:31], v[20:23], v[28:31]
  buffer_load_dwordx4 a[28:31], v1, s[44:47], s7 offen offset:256 nt
  s_mov_b64 exec, s[52:53]
  ds_write_b128 v6, v[24:27] offset:0
  s_mov_b64 exec, -1
  v_mfma_f32_16x16x32_bf16 v[24:27], a[32:35], v[8:11], 0
  buffer_load_dwordx4 a[32:35], v1, s[44:47], s7 offen offset:512 nt
  v_mfma_f32_16x16x32_bf16 v[24:27], a[36:39], v[12:15], v[24:27]
  buffer_load_dwordx4 a[36:39], v1, s[44:47], s7 offen offset:768 nt
  v_mfma_f32_16x16x32_bf16 v[24:27], a[40:43], v[16:19], v[24:27]
  s_add_u32 s7, s6, 393216
  buffer_load_dwordx4 a[40:43], v1, s[44:47], s7 offen offset:0 nt
  v_mfma_f32_16x16x32_bf16 v[24:27], a[44:47], v[20:23], v[24:27]
  buffer_load_dwordx4 a[44:47], v1, s[44:47], s7 offen offset:256 nt
  s_mov_b64 exec, s[52:53]
  ds_write_b128 v6, v[28:31] offset:64
  s_mov_b64 exec, -1
  v_mfma_f32_16x16x32_bf16 v[28:31], a[48:51], v[8:11], 0
  buffer_load_dwordx4 a[48:51], v1, s[44:47], s7 offen offset:512 nt
  v_mfma_f32_16x16x32_bf16 v[28:31], a[52:55], v[12:15], v[28:31]
  buffer_load_dwordx4 a[52:55], v1, s[44:47], s7 offen offset:768 nt
  v_mfma_f32_16x16x32_bf16 v[28:31], a[56:59], v[16:19], v[28:31]
  s_add_u32 s7, s6, 376832
  buffer_load_dwordx4 a[56:59], v1, s[44:47], s7 offen offset:0 nt
  v_mfma_f32_16x16x32_bf16 v[28:31], a[60:63], v[20:23], v[28:31]
  buffer_load_dwordx4 a[60:63], v1, s[44:47], s7 offen offset:256 nt
  s_mov_b64 exec, s[52:53]
  ds_write_b128 v6, v[24:27] offset:128
  s_mov_b64 exec, -1
  v_mfma_f32_16x16x32_bf16 v[24:27], a[64:67], v[8:11], 0
  buffer_load_dwordx4 a[64:67], v1, s[44:47], s7 offen offset:512 nt
  v_mfma_f32_16x16x32_bf16 v[24:27], a[68:71], v[12:15], v[24:27]
  buffer_load_dwordx4 a[68:71], v1, s[44:47], s7 offen offset:768 nt
  v_mfma_f32_16x16x32_bf16 v[24:27], a[72:75], v[16:19], v[24:27]
  s_add_u32 s7, s6, 360448
  buffer_load_dwordx4 a[72:75], v1, s[44:47], s7 offen offset:0 nt
  v_mfma_f32_16x16x32_bf16 v[24:27], a[76:79], v[20:23], v[24:27]
  buffer_load_dwordx4 a[76:79], v1, s[44:47], s7 offen offset:256 nt
  s_mov_b64 exec, s[52:53]
  ds_write_b128 v6, v[28:31] offset:192
  s_mov_b64 exec, -1
  v_mfma_f32_16x16x32_bf16 v[28:31], a[80:83], v[8:11], 0
  buffer_load_dwordx4 a[80:83], v1, s[44:47], s7 offen offset:512 nt
  v_mfma_f32_16x16x32_bf16 v[28:31], a[84:87], v[12:15], v[28:31]
  buffer_load_dwordx4 a[84:87], v1, s[44:47], s7 offen offset:768 nt
  v_mfma_f32_16x16x32_bf16 v[28:31], a[88:91], v[16:19], v[28:31]
  s_add_u32 s7, s6, 344064
  buffer_load_dwordx4 a[88:91], v1, s[44:47], s7 offen offset:0 nt
  v_mfma_f32_16x16x32_bf16 v[28:31], a[92:95], v[20:23], v[28:31]
  buffer_load_dwordx4 a[92:95], v1, s[44:47], s7 offen offset:256 nt
  s_mov_b64 exec, s[52:53]
  ds_write_b128 v6, v[24:27] offset:256
  s_mov_b64 exec, -1
  v_mfma_f32_16x16x32_bf16 v[24:27], a[96:99], v[8:11], 0
  buffer_load_dwordx4 a[96:99], v1, s[44:47], s7 offen offset:512 nt
  v_mfma_f32_16x16x32_bf16 v[24:27], a[100:103], v[12:15], v[24:27]
  buffer_load_dwordx4 a[100:103], v1, s[44:47], s7 offen offset:768 nt
  v_mfma_f32_16x16x32_bf16 v[24:27], a[104:107], v[16:19], v[24:27]
  s_add_u32 s7, s6, 327680
  buffer_load_dwordx4 a[104:107], v1, s[44:47], s7 offen offset:0 nt
  v_mfma_f32_16x16x32_bf16 v[24:27], a[108:111], v[20:23], v[24:27]
  buffer_load_dwordx4 a[108:111], v1, s[44:47], s7 offen offset:256 nt
  s_mov_b64 exec, s[52:53]
  ds_write_b128 v6, v[28:31] offset:320
  s_mov_b64 exec, -1
  v_mfma_f32_16x16x32_bf16 v[28:31], a[112:115], v[8:11], 0
  buffer_load_dwordx4 a[112:115], v1, s[44:47], s7 offen offset:512 nt
  v_mfma_f32_16x16x32_bf16 v[28:31], a[116:119], v[12:15], v[28:31]
  buffer_load_dwordx4 a[116:119], v1, s[44:47], s7 offen offset:768 nt
  v_mfma_f32_16x16x32_bf16 v[28:31], a[120:123], v[16:19], v[28:31]
  s_add_u32 s7, s6, 311296
  buffer_load_dwordx4 a[120:123], v1, s[44:47], s7 offen offset:0 nt
  v_mfma_f32_16x16x32_bf16 v[28:31], a[124:127], v[20:23], v[28:31]
  buffer_load_dwordx4 a[124:127], v1, s[44:47], s7 offen offset:256 nt
  s_mov_b64 exec, s[52:53]
  ds_write_b128 v6, v[24:27] offset:384
  s_mov_b64 exec, -1
  v_mfma_f32_16x16x32_bf16 v[24:27], a[128:131], v[8:11], 0
  buffer_load_dwordx4 a[128:131], v1, s[44:47], s7 offen offset:512 nt
  v_mfma_f32_16x16x32_bf16 v[24:27], a[132:135], v[12:15], v[24:27]
  buffer_load_dwordx4 a[132:135], v1, s[44:47], s7 offen offset:768 nt
  v_mfma_f32_16x16x32_bf16 v[24:27], a[136:139], v[16:19], v[24:27]
  s_add_u32 s7, s6, 294912
  buffer_load_dwordx4 a[136:139], v1, s[44:47], s7 offen offset:0 nt
  v_mfma_f32_16x16x32_bf16 v[24:27], a[140:143], v[20:23], v[24:27]
  buffer_load_dwordx4 a[140:143], v1, s[44:47], s7 offen offset:256 nt
  s_mov_b64 exec, s[52:53]
  ds_write_b128 v6, v[28:31] offset:448
  s_mov_b64 exec, -1
  v_mfma_f32_16x16x32_bf16 v[28:31], a[144:147], v[8:11], 0
  buffer_load_dwordx4 a[144:147], v1, s[44:47], s7 offen offset:512 nt
  v_mfma_f32_16x16x32_bf16 v[28:31], a[148:151], v[12:15], v[28:31]
  buffer_load_dwordx4 a[148:151], v1, s[44:47], s7 offen offset:768 nt
  v_mfma_f32_16x16x32_bf16 v[28:31], a[152:155], v[16:19], v[28:31]
  s_add_u32 s7, s6, 278528
  buffer_load_dwordx4 a[152:155], v1, s[44:47], s7 offen offset:0 nt
  v_mfma_f32_16x16x32_bf16 v[28:31], a[156:159], v[20:23], v[28:31]
  buffer_load_dwordx4 a[156:159], v1, s[44:47], s7 offen offset:256 nt
  s_mov_b64 exec, s[52:53]
  ds_write_b128 v6, v[24:27] offset:512
  s_mov_b64 exec, -1
  v_mfma_f32_16x16x32_bf16 v[24:27], a[160:163], v[8:11], 0
  buffer_load_dwordx4 a[160:163], v1, s[44:47], s7 offen offset:512 nt
  v_mfma_f32_16x16x32_bf16 v[24:27], a[164:167], v[12:15], v[24:27]
  buffer_load_dwordx4 a[164:167], v1, s[44:47], s7 offen offset:768 nt
  v_mfma_f32_16x16x32_bf16 v[24:27], a[168:171], v[16:19], v[24:27]
  s_add_u32 s7, s6, 262144
  buffer_load_dwordx4 a[168:171], v1, s[44:47], s7 offen offset:0 nt
  v_mfma_f32_16x16x32_bf16 v[24:27], a[172:175], v[20:23], v[24:27]
  buffer_load_dwordx4 a[172:175], v1, s[44:47], s7 offen offset:256 nt
  s_mov_b64 exec, s[52:53]
  ds_write_b128 v6, v[28:31] offset:576
  s_mov_b64 exec, -1
  v_mfma_f32_16x16x32_bf16 v[28:31], a[176:179], v[8:11], 0
  buffer_load_dwordx4 a[176:179], v1, s[44:47], s7 offen offset:512 nt
  v_mfma_f32_16x16x32_bf16 v[28:31], a[180:183], v[12:15], v[28:31]
  buffer_load_dwordx4 a[180:183], v1, s[44:47], s7 offen offset:768 nt
  v_mfma_f32_16x16x32_bf16 v[28:31], a[184:187], v[16:19], v[28:31]
  s_add_u32 s7, s6, 245760
  buffer_load_dwordx4 a[184:187], v1, s[44:47], s7 offen offset:0 nt
  v_mfma_f32_16x16x32_bf16 v[28:31], a[188:191], v[20:23], v[28:31]
  buffer_load_dwordx4 a[188:191], v1, s[44:47], s7 offen offset:256 nt
  s_mov_b64 exec, s[52:53]
  ds_write_b128 v6, v[24:27] offset:640
  s_mov_b64 exec, -1
  v_mfma_f32_16x16x32_bf16 v[24:27], a[192:195], v[8:11], 0
  buffer_load_dwordx4 a[192:195], v1, s[44:47], s7 offen offset:512 nt
  v_mfma_f32_16x16x32_bf16 v[24:27], a[196:199], v[12:15], v[24:27]
  buffer_load_dwordx4 a[196:199], v1, s[44:47], s7 offen offset:768 nt
  v_mfma_f32_16x16x32_bf16 v[24:27], a[200:203], v[16:19], v[24:27]
  v_mfma_f32_16x16x32_bf16 v[24:27], a[204:207], v[20:23], v[24:27]
  s_mov_b64 exec, s[52:53]
  ds_write_b128 v6, v[28:31] offset:704
  s_mov_b64 exec, -1
  v_mfma_f32_16x16x32_bf16 v[28:31], a[208:211], v[8:11], 0
  v_mfma_f32_16x16x32_bf16 v[28:31], a[212:215], v[12:15], v[28:31]
  v_mfma_f32_16x16x32_bf16 v[28:31], a[216:219], v[16:19], v[28:31]
  v_mfma_f32_16x16x32_bf16 v[28:31], a[220:223], v[20:23], v[28:31]
  s_mov_b64 exec, s[52:53]
  ds_write_b128 v6, v[24:27] offset:768
  s_mov_b64 exec, -1
  v_mfma_f32_16x16x32_bf16 v[24:27], a[224:227], v[8:11], 0
  v_mfma_f32_16x16x32_bf16 v[24:27], a[228:231], v[12:15], v[24:27]
  v_mfma_f32_16x16x32_bf16 v[24:27], a[232:235], v[16:19], v[24:27]
  v_mfma_f32_16x16x32_bf16 v[24:27], a[236:239], v[20:23], v[24:27]
  s_mov_b64 exec, s[52:53]
  ds_write_b128 v6, v[28:31] offset:832
  s_mov_b64 exec, -1
  v_mfma_f32_16x16x32_bf16 v[28:31], a[240:243], v[8:11], 0
  v_mfma_f32_16x16x32_bf16 v[28:31], a[244:247], v[12:15], v[28:31]
  v_mfma_f32_16x16x32_bf16 v[28:31], a[248:251], v[16:19], v[28:31]
  v_mfma_f32_16x16x32_bf16 v[28:31], a[252:255], v[20:23], v[28:31]
  s_mov_b64 exec, s[52:53]
  ds_write_b128 v6, v[24:27] offset:896
  s_mov_b64 exec, -1
  v_mfma_f32_16x16x32_bf16 v[24:27], v[56:59], v[8:11], 0
  v_mfma_f32_16x16x32_bf16 v[24:27], v[60:63], v[12:15], v[24:27]
  v_mfma_f32_16x16x32_bf16 v[24:27], v[64:67], v[16:19], v[24:27]
  v_mfma_f32_16x16x32_bf16 v[24:27], v[68:71], v[20:23], v[24:27]
  s_mov_b64 exec, s[52:53]
  ds_write_b128 v6, v[28:31] offset:960
  s_mov_b64 exec, -1
  v_mfma_f32_16x16x32_bf16 v[28:31], v[72:75], v[8:11], 0
  v_mfma_f32_16x16x32_bf16 v[28:31], v[76:79], v[12:15], v[28:31]
  v_mfma_f32_16x16x32_bf16 v[28:31], v[80:83], v[16:19], v[28:31]
  v_mfma_f32_16x16x32_bf16 v[28:31], v[84:87], v[20:23], v[28:31]
  s_mov_b64 exec, s[52:53]
  ds_write_b128 v6, v[24:27] offset:1024
  s_mov_b64 exec, -1
  v_mfma_f32_16x16x32_bf16 v[24:27], v[88:91], v[8:11], 0
  v_mfma_f32_16x16x32_bf16 v[24:27], v[92:95], v[12:15], v[24:27]
  v_mfma_f32_16x16x32_bf16 v[24:27], v[96:99], v[16:19], v[24:27]
  v_mfma_f32_16x16x32_bf16 v[24:27], v[100:103], v[20:23], v[24:27]
  s_mov_b64 exec, s[52:53]
  ds_write_b128 v6, v[28:31] offset:1088
  s_mov_b64 exec, -1
  v_mfma_f32_16x16x32_bf16 v[28:31], v[104:107], v[8:11], 0
  v_mfma_f32_16x16x32_bf16 v[28:31], v[108:111], v[12:15], v[28:31]
  v_mfma_f32_16x16x32_bf16 v[28:31], v[112:115], v[16:19], v[28:31]
  v_mfma_f32_16x16x32_bf16 v[28:31], v[116:119], v[20:23], v[28:31]
  s_mov_b64 exec, s[52:53]
  ds_write_b128 v6, v[24:27] offset:1152
  s_mov_b64 exec, -1
  v_mfma_f32_16x16x32_bf16 v[24:27], v[120:123], v[8:11], 0
  v_mfma_f32_16x16x32_bf16 v[24:27], v[124:127], v[12:15], v[24:27]
  v_mfma_f32_16x16x32_bf16 v[24:27], v[128:131], v[16:19], v[24:27]
  v_mfma_f32_16x16x32_bf16 v[24:27], v[132:135], v[20:23], v[24:27]
  s_mov_b64 exec, s[52:53]
  ds_write_b128 v6, v[28:31] offset:1216
  s_mov_b64 exec, -1
  v_mfma_f32_16x16x32_bf16 v[28:31], v[136:139], v[8:11], 0
  v_mfma_f32_16x16x32_bf16 v[28:31], v[140:143], v[12:15], v[28:31]
  v_mfma_f32_16x16x32_bf16 v[28:31], v[144:147], v[16:19], v[28:31]
  v_mfma_f32_16x16x32_bf16 v[28:31], v[148:151], v[20:23], v[28:31]
  s_mov_b64 exec, s[52:53]
  ds_write_b128 v6, v[24:27] offset:1280
  s_mov_b64 exec, -1
  v_mfma_f32_16x16x32_bf16 v[24:27], v[152:155], v[8:11], 0
  v_mfma_f32_16x16x32_bf16 v[24:27], v[156:159], v[12:15], v[24:27]
  v_mfma_f32_16x16x32_bf16 v[24:27], v[160:163], v[16:19], v[24:27]
  v_mfma_f32_16x16x32_bf16 v[24:27], v[164:167], v[20:23], v[24:27]
  s_mov_b64 exec, s[52:53]
  ds_write_b128 v6, v[28:31] offset:1344
  s_mov_b64 exec, -1
  ds_read_b128 v[32:35], v52 offset:1024
  ds_read_b128 v[36:39], v53 offset:1024
  ds_read_b128 v[40:43], v54 offset:1024
  ds_read_b128 v[44:47], v55 offset:1024
  s_waitcnt lgkmcnt(0)
  v_mfma_f32_16x16x32_bf16 v[28:31], v[32:35], v[8:11], 0
  v_mfma_f32_16x16x32_bf16 v[28:31], v[36:39], v[12:15], v[28:31]
  v_mfma_f32_16x16x32_bf16 v[28:31], v[40:43], v[16:19], v[28:31]
  v_mfma_f32_16x16x32_bf16 v[28:31], v[44:47], v[20:23], v[28:31]
  s_mov_b64 exec, s[52:53]
  ds_write_b128 v6, v[24:27] offset:1408
  s_mov_b64 exec, -1
  ds_read_b128 v[32:35], v52 offset:5120
  ds_read_b128 v[36:39], v53 offset:5120
  ds_read_b128 v[40:43], v54 offset:5120
  ds_read_b128 v[44:47], v55 offset:5120
  s_waitcnt lgkmcnt(0)
  v_mfma_f32_16x16x32_bf16 v[24:27], v[32:35], v[8:11], 0
  v_mfma_f32_16x16x32_bf16 v[24:27], v[36:39], v[12:15], v[24:27]
  v_mfma_f32_16x16x32_bf16 v[24:27], v[40:43], v[16:19], v[24:27]
  v_mfma_f32_16x16x32_bf16 v[24:27], v[44:47], v[20:23], v[24:27]
  s_mov_b64 exec, s[52:53]
  ds_write_b128 v6, v[28:31] offset:1472
  s_mov_b64 exec, -1
  ds_read_b128 v[32:35], v52 offset:9216
  ds_read_b128 v[36:39], v53 offset:9216
  ds_read_b128 v[40:43], v54 offset:9216
  ds_read_b128 v[44:47], v55 offset:9216
  s_waitcnt lgkmcnt(0)
  v_mfma_f32_16x16x32_bf16 v[28:31], v[32:35], v[8:11], 0
  v_mfma_f32_16x16x32_bf16 v[28:31], v[36:39], v[12:15], v[28:31]
  v_mfma_f32_16x16x32_bf16 v[28:31], v[40:43], v[16:19], v[28:31]
  v_mfma_f32_16x16x32_bf16 v[28:31], v[44:47], v[20:23], v[28:31]
  s_mov_b64 exec, s[52:53]
  ds_write_b128 v6, v[24:27] offset:1536
  s_mov_b64 exec, -1
  ds_read_b128 v[32:35], v52 offset:13312
  ds_read_b128 v[36:39], v53 offset:13312
  ds_read_b128 v[40:43], v54 offset:13312
  ds_read_b128 v[44:47], v55 offset:13312
  s_waitcnt lgkmcnt(0)
  v_mfma_f32_16x16x32_bf16 v[24:27], v[32:35], v[8:11], 0
  v_mfma_f32_16x16x32_bf16 v[24:27], v[36:39], v[12:15], v[24:27]
  v_mfma_f32_16x16x32_bf16 v[24:27], v[40:43], v[16:19], v[24:27]
  v_mfma_f32_16x16x32_bf16 v[24:27], v[44:47], v[20:23], v[24:27]
  s_mov_b64 exec, s[52:53]
  ds_write_b128 v6, v[28:31] offset:1600
  s_mov_b64 exec, -1
  ds_read_b128 v[32:35], v52 offset:17408
  ds_read_b128 v[36:39], v53 offset:17408
  ds_read_b128 v[40:43], v54 offset:17408
  ds_read_b128 v[44:47], v55 offset:17408
  s_waitcnt lgkmcnt(0)
  v_mfma_f32_16x16x32_bf16 v[28:31], v[32:35], v[8:11], 0
  v_mfma_f32_16x16x32_bf16 v[28:31], v[36:39], v[12:15], v[28:31]
  v_mfma_f32_16x16x32_bf16 v[28:31], v[40:43], v[16:19], v[28:31]
  v_mfma_f32_16x16x32_bf16 v[28:31], v[44:47], v[20:23], v[28:31]
  s_mov_b64 exec, s[52:53]
  ds_write_b128 v6, v[24:27] offset:1664
  s_mov_b64 exec, -1
  ds_read_b128 v[32:35], v52 offset:21504
  ds_read_b128 v[36:39], v53 offset:21504
  ds_read_b128 v[40:43], v54 offset:21504
  ds_read_b128 v[44:47], v55 offset:21504
  s_waitcnt lgkmcnt(0)
  v_mfma_f32_16x16x32_bf16 v[24:27], v[32:35], v[8:11], 0
  v_mfma_f32_16x16x32_bf16 v[24:27], v[36:39], v[12:15], v[24:27]
  v_mfma_f32_16x16x32_bf16 v[24:27], v[40:43], v[16:19], v[24:27]
  v_mfma_f32_16x16x32_bf16 v[24:27], v[44:47], v[20:23], v[24:27]
  s_mov_b64 exec, s[52:53]
  ds_write_b128 v6, v[28:31] offset:1728
  s_mov_b64 exec, -1
  ds_read_b128 v[32:35], v52 offset:25600
  ds_read_b128 v[36:39], v53 offset:25600
  ds_read_b128 v[40:43], v54 offset:25600
  ds_read_b128 v[44:47], v55 offset:25600
  s_waitcnt lgkmcnt(0)
  v_mfma_f32_16x16x32_bf16 v[28:31], v[32:35], v[8:11], 0
  v_mfma_f32_16x16x32_bf16 v[28:31], v[36:39], v[12:15], v[28:31]
  v_mfma_f32_16x16x32_bf16 v[28:31], v[40:43], v[16:19], v[28:31]
  v_mfma_f32_16x16x32_bf16 v[28:31], v[44:47], v[20:23], v[28:31]
  s_mov_b64 exec, s[52:53]
  ds_write_b128 v6, v[24:27] offset:1792
  s_mov_b64 exec, -1
  ds_read_b128 v[32:35], v52 offset:29696
  ds_read_b128 v[36:39], v53 offset:29696
  ds_read_b128 v[40:43], v54 offset:29696
  ds_read_b128 v[44:47], v55 offset:29696
  s_waitcnt lgkmcnt(0)
  v_mfma_f32_16x16x32_bf16 v[24:27], v[32:35], v[8:11], 0
  v_mfma_f32_16x16x32_bf16 v[24:27], v[36:39], v[12:15], v[24:27]
  v_mfma_f32_16x16x32_bf16 v[24:27], v[40:43], v[16:19], v[24:27]
  v_mfma_f32_16x16x32_bf16 v[24:27], v[44:47], v[20:23], v[24:27]
  s_mov_b64 exec, s[52:53]
  ds_write_b128 v6, v[28:31] offset:1856
  s_mov_b64 exec, -1
  ds_read_b128 v[32:35], v52 offset:33792
  ds_read_b128 v[36:39], v53 offset:33792
  ds_read_b128 v[40:43], v54 offset:33792
  ds_read_b128 v[44:47], v55 offset:33792
  s_waitcnt lgkmcnt(0)
  v_mfma_f32_16x16x32_bf16 v[28:31], v[32:35], v[8:11], 0
  v_mfma_f32_16x16x32_bf16 v[28:31], v[36:39], v[12:15], v[28:31]
  v_mfma_f32_16x16x32_bf16 v[28:31], v[40:43], v[16:19], v[28:31]
  v_mfma_f32_16x16x32_bf16 v[28:31], v[44:47], v[20:23], v[28:31]
  s_mov_b64 exec, s[52:53]
  ds_write_b128 v6, v[24:27] offset:1920
  s_mov_b64 exec, -1
  s_mov_b64 exec, s[52:53]
  s_nop 3
  ds_write_b128 v6, v[28:31] offset:1984
  s_mov_b64 exec, -1
  v_lshlrev_b32 v4, 5, v0
  s_lshl_b32 s12, s3, 11
  v_add_u32 v4, s12, v4
  s_waitcnt lgkmcnt(0)
  ds_read_b128 v[40:43], v4
  ds_read_b128 v[44:47], v4 offset:16
  s_waitcnt lgkmcnt(0)
  v_cvt_pk_bf16_f32 v32, v40, v41
  v_cvt_pk_bf16_f32 v33, v42, v43
  v_cvt_pk_bf16_f32 v34, v44, v45
  v_cvt_pk_bf16_f32 v35, v46, v47
  v_lshlrev_b32 v40, 16, v32
  v_and_b32 v41, 0xffff0000, v32
  v_lshlrev_b32 v42, 16, v33
  v_and_b32 v43, 0xffff0000, v33
  v_lshlrev_b32 v44, 16, v34
  v_and_b32 v45, 0xffff0000, v34
  v_lshlrev_b32 v46, 16, v35
  v_and_b32 v47, 0xffff0000, v35
  v_mul_f32 v40, s9, v40
  v_mul_f32 v41, s9, v41
  v_mul_f32 v42, s9, v42
  v_mul_f32 v43, s9, v43
  v_mul_f32 v44, s9, v44
  v_mul_f32 v45, s9, v45
  v_mul_f32 v46, s9, v46
  v_mul_f32 v47, s9, v47
  v_cvt_pk_bf16_f32 v32, v40, v41
  v_cvt_pk_bf16_f32 v33, v42, v43
  v_cvt_pk_bf16_f32 v34, v44, v45
  v_cvt_pk_bf16_f32 v35, v46, v47
  v_lshlrev_b32 v40, 16, v32
  v_and_b32 v41, 0xffff0000, v32
  v_lshlrev_b32 v42, 16, v33
  v_and_b32 v43, 0xffff0000, v33
  v_lshlrev_b32 v44, 16, v34
  v_and_b32 v45, 0xffff0000, v34
  v_lshlrev_b32 v46, 16, v35
  v_and_b32 v47, 0xffff0000, v35
  v_max3_f32 v48, v40, v41, v42
  v_max3_f32 v48, v48, v43, v44
  v_max3_f32 v48, v48, v45, v46
  v_max_f32 v48, v48, v47
  s_nop 1
  v_max_f32_dpp v48, v48, v48 quad_perm:[1,0,3,2] row_mask:0xf bank_mask:0xf
  s_nop 1
  v_max_f32_dpp v48, v48, v48 quad_perm:[2,3,0,1] row_mask:0xf bank_mask:0xf
  s_nop 1
  v_max_f32_dpp v48, v48, v48 row_half_mirror row_mask:0xf bank_mask:0xf
  s_nop 1
  v_max_f32_dpp v48, v48, v48 row_mirror row_mask:0xf bank_mask:0xf
  v_mov_b32 v5, v48
  s_nop 1
  v_permlane16_swap_b32 v5, v48
  v_max_f32 v48, v48, v5
  v_mov_b32 v5, v48
  s_nop 1
  v_permlane32_swap_b32 v5, v48
  v_max_f32 v48, v48, v5
  v_mul_f32 v5, s8, v48
  v_fma_f32 v40, v40, s8, -v5
  v_fma_f32 v41, v41, s8, -v5
  v_fma_f32 v42, v42, s8, -v5
  v_fma_f32 v43, v43, s8, -v5
  v_fma_f32 v44, v44, s8, -v5
  v_fma_f32 v45, v45, s8, -v5
  v_fma_f32 v46, v46, s8, -v5
  v_fma_f32 v47, v47, s8, -v5
  v_exp_f32 v40, v40
  v_exp_f32 v41, v41
  v_exp_f32 v42, v42
  v_exp_f32 v43, v43
  v_exp_f32 v44, v44
  v_exp_f32 v45, v45
  v_exp_f32 v46, v46
  v_exp_f32 v47, v47
  v_add_f32 v49, v40, v41
  v_add_f32 v49, v49, v42
  v_add_f32 v49, v49, v43
  v_add_f32 v49, v49, v44
  v_add_f32 v49, v49, v45
  v_add_f32 v49, v49, v46
  v_add_f32 v49, v49, v47
  v_cvt_pk_bf16_f32 v32, v40, v41
  v_cvt_pk_bf16_f32 v33, v42, v43
  v_cvt_pk_bf16_f32 v34, v44, v45
  v_cvt_pk_bf16_f32 v35, v46, v47
  v_lshlrev_b32 v40, 16, v32
  v_and_b32 v41, 0xffff0000, v32
  v_lshlrev_b32 v42, 16, v33
  v_and_b32 v43, 0xffff0000, v33
  v_lshlrev_b32 v44, 16, v34
  v_and_b32 v45, 0xffff0000, v34
  v_lshlrev_b32 v46, 16, v35
  v_and_b32 v47, 0xffff0000, v35
  ds_write_b128 v4, v[40:43]
  ds_write_b128 v4, v[44:47] offset:16
  v_add_f32_dpp v49, v49, v49 quad_perm:[1,0,3,2] row_mask:0xf bank_mask:0xf
  s_nop 1
  v_add_f32_dpp v49, v49, v49 quad_perm:[2,3,0,1] row_mask:0xf bank_mask:0xf
  s_nop 1
  v_add_f32_dpp v49, v49, v49 row_half_mirror row_mask:0xf bank_mask:0xf
  s_nop 1
  v_add_f32_dpp v49, v49, v49 row_mirror row_mask:0xf bank_mask:0xf
  v_mov_b32 v5, v49
  s_nop 1
  v_permlane16_swap_b32 v5, v49
  v_add_f32 v49, v49, v5
  v_mov_b32 v5, v49
  s_nop 1
  v_permlane32_swap_b32 v5, v49
  v_add_f32 v49, v49, v5
  v_mov_b32 v40, 0
  v_mov_b32 v41, 0
  v_mov_b32 v42, 0
  v_mov_b32 v43, 0
  v_mov_b32 v44, 0
  v_mov_b32 v45, 0
  v_mov_b32 v46, 0
  v_mov_b32 v47, 0
  s_waitcnt lgkmcnt(0)
  v_lshrrev_b32 v4, 3, v0
  v_lshlrev_b32 v4, 10, v4
  v_and_b32 v5, 7, v0
  v_lshl_add_u32 v4, v5, 4, v4
  s_lshl_b32 s12, s4, 17
  s_lshl_b32 s13, s5, 7
  s_add_u32 s12, s12, s13
  s_lshl_b32 s13, s3, 15
  s_add_u32 s12, s12, s13
  v_add_u32 v4, s12, v4
  global_load_dwordx4 v[8:11], v4, s[24:25]
  v_add_u32 v4, 0x2000, v4
  global_load_dwordx4 v[12:15], v4, s[24:25]
  v_add_u32 v4, 0x2000, v4
  global_load_dwordx4 v[16:19], v4, s[24:25]
  v_add_u32 v4, 0x2000, v4
  global_load_dwordx4 v[20:23], v4, s[24:25]
  ds_read_b128 v[32:35], v6 offset:1792
  s_waitcnt lgkmcnt(0)
  ds_read_b128 v[36:39], v6 offset:1856
  v_lshrrev_b32 v50, 16, v32
  v_dot2c_f32_bf16 v40, v168, v50
  v_dot2c_f32_bf16 v41, v168, v32
  v_dot2c_f32_bf16 v42, v169, v50
  v_dot2c_f32_bf16 v43, v169, v32
  v_dot2c_f32_bf16 v44, v170, v50
  v_dot2c_f32_bf16 v45, v170, v32
  v_dot2c_f32_bf16 v46, v171, v50
  v_dot2c_f32_bf16 v47, v171, v32
  v_lshrrev_b32 v51, 16, v33
  v_dot2c_f32_bf16 v40, v172, v51
  v_dot2c_f32_bf16 v41, v172, v33
  v_dot2c_f32_bf16 v42, v173, v51
  v_dot2c_f32_bf16 v43, v173, v33
  v_dot2c_f32_bf16 v44, v174, v51
  v_dot2c_f32_bf16 v45, v174, v33
  v_dot2c_f32_bf16 v46, v175, v51
  v_dot2c_f32_bf16 v47, v175, v33
  v_lshrrev_b32 v50, 16, v34
  v_dot2c_f32_bf16 v40, v176, v50
  v_dot2c_f32_bf16 v41, v176, v34
  v_dot2c_f32_bf16 v42, v177, v50
  v_dot2c_f32_bf16 v43, v177, v34
  v_dot2c_f32_bf16 v44, v178, v50
  v_dot2c_f32_bf16 v45, v178, v34
  v_dot2c_f32_bf16 v46, v179, v50
  v_dot2c_f32_bf16 v47, v179, v34
  v_lshrrev_b32 v51, 16, v35
  v_dot2c_f32_bf16 v40, v180, v51
  v_dot2c_f32_bf16 v41, v180, v35
  v_dot2c_f32_bf16 v42, v181, v51
  v_dot2c_f32_bf16 v43, v181, v35
  v_dot2c_f32_bf16 v44, v182, v51
  v_dot2c_f32_bf16 v45, v182, v35
  v_dot2c_f32_bf16 v46, v183, v51
  v_dot2c_f32_bf16 v47, v183, v35
  s_waitcnt lgkmcnt(0)
  ds_read_b128 v[32:35], v6 offset:1920
  v_lshrrev_b32 v50, 16, v36
  v_dot2c_f32_bf16 v40, v184, v50
  v_dot2c_f32_bf16 v41, v184, v36
  v_dot2c_f32_bf16 v42, v185, v50
  v_dot2c_f32_bf16 v43, v185, v36
  v_dot2c_f32_bf16 v44, v186, v50
  v_dot2c_f32_bf16 v45, v186, v36
  v_dot2c_f32_bf16 v46, v187, v50
  v_dot2c_f32_bf16 v47, v187, v36
  v_lshrrev_b32 v51, 16, v37
  v_dot2c_f32_bf16 v40, v188, v51
  v_dot2c_f32_bf16 v41, v188, v37
  v_dot2c_f32_bf16 v42, v189, v51
  v_dot2c_f32_bf16 v43, v189, v37
  v_dot2c_f32_bf16 v44, v190, v51
  v_dot2c_f32_bf16 v45, v190, v37
  v_dot2c_f32_bf16 v46, v191, v51
  v_dot2c_f32_bf16 v47, v191, v37
  v_lshrrev_b32 v50, 16, v38
  v_dot2c_f32_bf16 v40, v192, v50
  v_dot2c_f32_bf16 v41, v192, v38
  v_dot2c_f32_bf16 v42, v193, v50
  v_dot2c_f32_bf16 v43, v193, v38
  v_dot2c_f32_bf16 v44, v194, v50
  v_dot2c_f32_bf16 v45, v194, v38
  v_dot2c_f32_bf16 v46, v195, v50
  v_dot2c_f32_bf16 v47, v195, v38
  v_lshrrev_b32 v51, 16, v39
  v_dot2c_f32_bf16 v40, v196, v51
  v_dot2c_f32_bf16 v41, v196, v39
  v_dot2c_f32_bf16 v42, v197, v51
  v_dot2c_f32_bf16 v43, v197, v39
  v_dot2c_f32_bf16 v44, v198, v51
  v_dot2c_f32_bf16 v45, v198, v39
  v_dot2c_f32_bf16 v46, v199, v51
  v_dot2c_f32_bf16 v47, v199, v39
  s_waitcnt lgkmcnt(0)
  ds_read_b128 v[36:39], v6 offset:1984
  v_lshrrev_b32 v50, 16, v32
  v_dot2c_f32_bf16 v40, v200, v50
  v_dot2c_f32_bf16 v41, v200, v32
  v_dot2c_f32_bf16 v42, v201, v50
  v_dot2c_f32_bf16 v43, v201, v32
  v_dot2c_f32_bf16 v44, v202, v50
  v_dot2c_f32_bf16 v45, v202, v32
  v_dot2c_f32_bf16 v46, v203, v50
  v_dot2c_f32_bf16 v47, v203, v32
  v_lshrrev_b32 v51, 16, v33
  v_dot2c_f32_bf16 v40, v204, v51
  v_dot2c_f32_bf16 v41, v204, v33
  v_dot2c_f32_bf16 v42, v205, v51
  v_dot2c_f32_bf16 v43, v205, v33
  v_dot2c_f32_bf16 v44, v206, v51
  v_dot2c_f32_bf16 v45, v206, v33
  v_dot2c_f32_bf16 v46, v207, v51
  v_dot2c_f32_bf16 v47, v207, v33
  v_lshrrev_b32 v50, 16, v34
  v_dot2c_f32_bf16 v40, v208, v50
  v_dot2c_f32_bf16 v41, v208, v34
  v_dot2c_f32_bf16 v42, v209, v50
  v_dot2c_f32_bf16 v43, v209, v34
  v_dot2c_f32_bf16 v44, v210, v50
  v_dot2c_f32_bf16 v45, v210, v34
  v_dot2c_f32_bf16 v46, v211, v50
  v_dot2c_f32_bf16 v47, v211, v34
  v_lshrrev_b32 v51, 16, v35
  v_dot2c_f32_bf16 v40, v212, v51
  v_dot2c_f32_bf16 v41, v212, v35
  v_dot2c_f32_bf16 v42, v213, v51
  v_dot2c_f32_bf16 v43, v213, v35
  v_dot2c_f32_bf16 v44, v214, v51
  v_dot2c_f32_bf16 v45, v214, v35
  v_dot2c_f32_bf16 v46, v215, v51
  v_dot2c_f32_bf16 v47, v215, v35
  s_waitcnt lgkmcnt(0)
  ds_read_b128 v[32:35], v6 offset:1728
  v_lshrrev_b32 v50, 16, v36
  v_dot2c_f32_bf16 v40, v216, v50
  v_dot2c_f32_bf16 v41, v216, v36
  v_dot2c_f32_bf16 v42, v217, v50
  v_dot2c_f32_bf16 v43, v217, v36
  v_dot2c_f32_bf16 v44, v218, v50
  v_dot2c_f32_bf16 v45, v218, v36
  v_dot2c_f32_bf16 v46, v219, v50
  v_dot2c_f32_bf16 v47, v219, v36
  v_lshrrev_b32 v51, 16, v37
  v_dot2c_f32_bf16 v40, v220, v51
  v_dot2c_f32_bf16 v41, v220, v37
  v_dot2c_f32_bf16 v42, v221, v51
  v_dot2c_f32_bf16 v43, v221, v37
  v_dot2c_f32_bf16 v44, v222, v51
  v_dot2c_f32_bf16 v45, v222, v37
  v_dot2c_f32_bf16 v46, v223, v51
  v_dot2c_f32_bf16 v47, v223, v37
  v_lshrrev_b32 v50, 16, v38
  v_dot2c_f32_bf16 v40, v224, v50
  v_dot2c_f32_bf16 v41, v224, v38
  v_dot2c_f32_bf16 v42, v225, v50
  v_dot2c_f32_bf16 v43, v225, v38
  v_dot2c_f32_bf16 v44, v226, v50
  v_dot2c_f32_bf16 v45, v226, v38
  v_dot2c_f32_bf16 v46, v227, v50
  v_dot2c_f32_bf16 v47, v227, v38
  v_lshrrev_b32 v51, 16, v39
  v_dot2c_f32_bf16 v40, v228, v51
  v_dot2c_f32_bf16 v41, v228, v39
  v_dot2c_f32_bf16 v42, v229, v51
  v_dot2c_f32_bf16 v43, v229, v39
  v_dot2c_f32_bf16 v44, v230, v51
  v_dot2c_f32_bf16 v45, v230, v39
  v_dot2c_f32_bf16 v46, v231, v51
  v_dot2c_f32_bf16 v47, v231, v39
  s_waitcnt lgkmcnt(0)
  ds_read_b128 v[36:39], v6 offset:1664
  s_waitcnt vmcnt(53)
  v_accvgpr_read_b32 v24, a0
  v_accvgpr_read_b32 v25, a1
  v_accvgpr_read_b32 v26, a2
  v_accvgpr_read_b32 v27, a3
  v_lshrrev_b32 v50, 16, v32
  v_dot2c_f32_bf16 v40, v24, v50
  v_dot2c_f32_bf16 v41, v24, v32
  v_dot2c_f32_bf16 v42, v25, v50
  v_dot2c_f32_bf16 v43, v25, v32
  v_dot2c_f32_bf16 v44, v26, v50
  v_dot2c_f32_bf16 v45, v26, v32
  v_dot2c_f32_bf16 v46, v27, v50
  v_dot2c_f32_bf16 v47, v27, v32
  s_waitcnt vmcnt(52)
  v_accvgpr_read_b32 v28, a4
  v_accvgpr_read_b32 v29, a5
  v_accvgpr_read_b32 v30, a6
  v_accvgpr_read_b32 v31, a7
  v_lshrrev_b32 v51, 16, v33
  v_dot2c_f32_bf16 v40, v28, v51
  v_dot2c_f32_bf16 v41, v28, v33
  v_dot2c_f32_bf16 v42, v29, v51
  v_dot2c_f32_bf16 v43, v29, v33
  v_dot2c_f32_bf16 v44, v30, v51
  v_dot2c_f32_bf16 v45, v30, v33
  v_dot2c_f32_bf16 v46, v31, v51
  v_dot2c_f32_bf16 v47, v31, v33
  ds_read_b128 v[24:27], v7 offset:37888
  s_waitcnt lgkmcnt(0)
  v_lshrrev_b32 v50, 16, v34
  v_dot2c_f32_bf16 v40, v24, v50
  v_dot2c_f32_bf16 v41, v24, v34
  v_dot2c_f32_bf16 v42, v25, v50
  v_dot2c_f32_bf16 v43, v25, v34
  v_dot2c_f32_bf16 v44, v26, v50
  v_dot2c_f32_bf16 v45, v26, v34
  v_dot2c_f32_bf16 v46, v27, v50
  v_dot2c_f32_bf16 v47, v27, v34
  ds_read_b128 v[28:31], v7 offset:38912
  s_waitcnt lgkmcnt(0)
  v_lshrrev_b32 v51, 16, v35
  v_dot2c_f32_bf16 v40, v28, v51
  v_dot2c_f32_bf16 v41, v28, v35
  v_dot2c_f32_bf16 v42, v29, v51
  v_dot2c_f32_bf16 v43, v29, v35
  v_dot2c_f32_bf16 v44, v30, v51
  v_dot2c_f32_bf16 v45, v30, v35
  v_dot2c_f32_bf16 v46, v31, v51
  v_dot2c_f32_bf16 v47, v31, v35
  s_waitcnt lgkmcnt(0)
  ds_read_b128 v[32:35], v6 offset:1600
  s_waitcnt vmcnt(51)
  v_accvgpr_read_b32 v24, a8
  v_accvgpr_read_b32 v25, a9
  v_accvgpr_read_b32 v26, a10
  v_accvgpr_read_b32 v27, a11
  v_lshrrev_b32 v50, 16, v36
  v_dot2c_f32_bf16 v40, v24, v50
  v_dot2c_f32_bf16 v41, v24, v36
  v_dot2c_f32_bf16 v42, v25, v50
  v_dot2c_f32_bf16 v43, v25, v36
  v_dot2c_f32_bf16 v44, v26, v50
  v_dot2c_f32_bf16 v45, v26, v36
  v_dot2c_f32_bf16 v46, v27, v50
  v_dot2c_f32_bf16 v47, v27, v36
  s_waitcnt vmcnt(50)
  v_accvgpr_read_b32 v28, a12
  v_accvgpr_read_b32 v29, a13
  v_accvgpr_read_b32 v30, a14
  v_accvgpr_read_b32 v31, a15
  v_lshrrev_b32 v51, 16, v37
  v_dot2c_f32_bf16 v40, v28, v51
  v_dot2c_f32_bf16 v41, v28, v37
  v_dot2c_f32_bf16 v42, v29, v51
  v_dot2c_f32_bf16 v43, v29, v37
  v_dot2c_f32_bf16 v44, v30, v51
  v_dot2c_f32_bf16 v45, v30, v37
  v_dot2c_f32_bf16 v46, v31, v51
  v_dot2c_f32_bf16 v47, v31, v37
  s_waitcnt vmcnt(49)
  v_accvgpr_read_b32 v24, a16
  v_accvgpr_read_b32 v25, a17
  v_accvgpr_read_b32 v26, a18
  v_accvgpr_read_b32 v27, a19
  v_lshrrev_b32 v50, 16, v38
  v_dot2c_f32_bf16 v40, v24, v50
  v_dot2c_f32_bf16 v41, v24, v38
  v_dot2c_f32_bf16 v42, v25, v50
  v_dot2c_f32_bf16 v43, v25, v38
  v_dot2c_f32_bf16 v44, v26, v50
  v_dot2c_f32_bf16 v45, v26, v38
  v_dot2c_f32_bf16 v46, v27, v50
  v_dot2c_f32_bf16 v47, v27, v38
  s_waitcnt vmcnt(48)
  v_accvgpr_read_b32 v28, a20
  v_accvgpr_read_b32 v29, a21
  v_accvgpr_read_b32 v30, a22
  v_accvgpr_read_b32 v31, a23
  v_lshrrev_b32 v51, 16, v39
  v_dot2c_f32_bf16 v40, v28, v51
  v_dot2c_f32_bf16 v41, v28, v39
  v_dot2c_f32_bf16 v42, v29, v51
  v_dot2c_f32_bf16 v43, v29, v39
  v_dot2c_f32_bf16 v44, v30, v51
  v_dot2c_f32_bf16 v45, v30, v39
  v_dot2c_f32_bf16 v46, v31, v51
  v_dot2c_f32_bf16 v47, v31, v39
  s_waitcnt lgkmcnt(0)
  ds_read_b128 v[36:39], v6 offset:1536
  s_waitcnt vmcnt(47)
  v_accvgpr_read_b32 v24, a24
  v_accvgpr_read_b32 v25, a25
  v_accvgpr_read_b32 v26, a26
  v_accvgpr_read_b32 v27, a27
  v_lshrrev_b32 v50, 16, v32
  v_dot2c_f32_bf16 v40, v24, v50
  v_dot2c_f32_bf16 v41, v24, v32
  v_dot2c_f32_bf16 v42, v25, v50
  v_dot2c_f32_bf16 v43, v25, v32
  v_dot2c_f32_bf16 v44, v26, v50
  v_dot2c_f32_bf16 v45, v26, v32
  v_dot2c_f32_bf16 v46, v27, v50
  v_dot2c_f32_bf16 v47, v27, v32
  s_waitcnt vmcnt(46)
  v_accvgpr_read_b32 v28, a28
  v_accvgpr_read_b32 v29, a29
  v_accvgpr_read_b32 v30, a30
  v_accvgpr_read_b32 v31, a31
  v_lshrrev_b32 v51, 16, v33
  v_dot2c_f32_bf16 v40, v28, v51
  v_dot2c_f32_bf16 v41, v28, v33
  v_dot2c_f32_bf16 v42, v29, v51
  v_dot2c_f32_bf16 v43, v29, v33
  v_dot2c_f32_bf16 v44, v30, v51
  v_dot2c_f32_bf16 v45, v30, v33
  v_dot2c_f32_bf16 v46, v31, v51
  v_dot2c_f32_bf16 v47, v31, v33
  s_waitcnt vmcnt(45)
  v_accvgpr_read_b32 v24, a32
  v_accvgpr_read_b32 v25, a33
  v_accvgpr_read_b32 v26, a34
  v_accvgpr_read_b32 v27, a35
  v_lshrrev_b32 v50, 16, v34
  v_dot2c_f32_bf16 v40, v24, v50
  v_dot2c_f32_bf16 v41, v24, v34
  v_dot2c_f32_bf16 v42, v25, v50
  v_dot2c_f32_bf16 v43, v25, v34
  v_dot2c_f32_bf16 v44, v26, v50
  v_dot2c_f32_bf16 v45, v26, v34
  v_dot2c_f32_bf16 v46, v27, v50
  v_dot2c_f32_bf16 v47, v27, v34
  s_waitcnt vmcnt(44)
  v_accvgpr_read_b32 v28, a36
  v_accvgpr_read_b32 v29, a37
  v_accvgpr_read_b32 v30, a38
  v_accvgpr_read_b32 v31, a39
  v_lshrrev_b32 v51, 16, v35
  v_dot2c_f32_bf16 v40, v28, v51
  v_dot2c_f32_bf16 v41, v28, v35
  v_dot2c_f32_bf16 v42, v29, v51
  v_dot2c_f32_bf16 v43, v29, v35
  v_dot2c_f32_bf16 v44, v30, v51
  v_dot2c_f32_bf16 v45, v30, v35
  v_dot2c_f32_bf16 v46, v31, v51
  v_dot2c_f32_bf16 v47, v31, v35
  s_waitcnt lgkmcnt(0)
  ds_read_b128 v[32:35], v6 offset:1472
  s_waitcnt vmcnt(43)
  v_accvgpr_read_b32 v24, a40
  v_accvgpr_read_b32 v25, a41
  v_accvgpr_read_b32 v26, a42
  v_accvgpr_read_b32 v27, a43
  v_lshrrev_b32 v50, 16, v36
  v_dot2c_f32_bf16 v40, v24, v50
  v_dot2c_f32_bf16 v41, v24, v36
  v_dot2c_f32_bf16 v42, v25, v50
  v_dot2c_f32_bf16 v43, v25, v36
  v_dot2c_f32_bf16 v44, v26, v50
  v_dot2c_f32_bf16 v45, v26, v36
  v_dot2c_f32_bf16 v46, v27, v50
  v_dot2c_f32_bf16 v47, v27, v36
  s_waitcnt vmcnt(42)
  v_accvgpr_read_b32 v28, a44
  v_accvgpr_read_b32 v29, a45
  v_accvgpr_read_b32 v30, a46
  v_accvgpr_read_b32 v31, a47
  v_lshrrev_b32 v51, 16, v37
  v_dot2c_f32_bf16 v40, v28, v51
  v_dot2c_f32_bf16 v41, v28, v37
  v_dot2c_f32_bf16 v42, v29, v51
  v_dot2c_f32_bf16 v43, v29, v37
  v_dot2c_f32_bf16 v44, v30, v51
  v_dot2c_f32_bf16 v45, v30, v37
  v_dot2c_f32_bf16 v46, v31, v51
  v_dot2c_f32_bf16 v47, v31, v37
  s_waitcnt vmcnt(41)
  v_accvgpr_read_b32 v24, a48
  v_accvgpr_read_b32 v25, a49
  v_accvgpr_read_b32 v26, a50
  v_accvgpr_read_b32 v27, a51
  v_lshrrev_b32 v50, 16, v38
  v_dot2c_f32_bf16 v40, v24, v50
  v_dot2c_f32_bf16 v41, v24, v38
  v_dot2c_f32_bf16 v42, v25, v50
  v_dot2c_f32_bf16 v43, v25, v38
  v_dot2c_f32_bf16 v44, v26, v50
  v_dot2c_f32_bf16 v45, v26, v38
  v_dot2c_f32_bf16 v46, v27, v50
  v_dot2c_f32_bf16 v47, v27, v38
  s_waitcnt vmcnt(40)
  v_accvgpr_read_b32 v28, a52
  v_accvgpr_read_b32 v29, a53
  v_accvgpr_read_b32 v30, a54
  v_accvgpr_read_b32 v31, a55
  v_lshrrev_b32 v51, 16, v39
  v_dot2c_f32_bf16 v40, v28, v51
  v_dot2c_f32_bf16 v41, v28, v39
  v_dot2c_f32_bf16 v42, v29, v51
  v_dot2c_f32_bf16 v43, v29, v39
  v_dot2c_f32_bf16 v44, v30, v51
  v_dot2c_f32_bf16 v45, v30, v39
  v_dot2c_f32_bf16 v46, v31, v51
  v_dot2c_f32_bf16 v47, v31, v39
  s_waitcnt lgkmcnt(0)
  ds_read_b128 v[36:39], v6 offset:1408
  s_waitcnt vmcnt(39)
  v_accvgpr_read_b32 v24, a56
  v_accvgpr_read_b32 v25, a57
  v_accvgpr_read_b32 v26, a58
  v_accvgpr_read_b32 v27, a59
  v_lshrrev_b32 v50, 16, v32
  v_dot2c_f32_bf16 v40, v24, v50
  v_dot2c_f32_bf16 v41, v24, v32
  v_dot2c_f32_bf16 v42, v25, v50
  v_dot2c_f32_bf16 v43, v25, v32
  v_dot2c_f32_bf16 v44, v26, v50
  v_dot2c_f32_bf16 v45, v26, v32
  v_dot2c_f32_bf16 v46, v27, v50
  v_dot2c_f32_bf16 v47, v27, v32
  s_waitcnt vmcnt(38)
  v_accvgpr_read_b32 v28, a60
  v_accvgpr_read_b32 v29, a61
  v_accvgpr_read_b32 v30, a62
  v_accvgpr_read_b32 v31, a63
  v_lshrrev_b32 v51, 16, v33
  v_dot2c_f32_bf16 v40, v28, v51
  v_dot2c_f32_bf16 v41, v28, v33
  v_dot2c_f32_bf16 v42, v29, v51
  v_dot2c_f32_bf16 v43, v29, v33
  v_dot2c_f32_bf16 v44, v30, v51
  v_dot2c_f32_bf16 v45, v30, v33
  v_dot2c_f32_bf16 v46, v31, v51
  v_dot2c_f32_bf16 v47, v31, v33
  s_waitcnt vmcnt(37)
  v_accvgpr_read_b32 v24, a64
  v_accvgpr_read_b32 v25, a65
  v_accvgpr_read_b32 v26, a66
  v_accvgpr_read_b32 v27, a67
  v_lshrrev_b32 v50, 16, v34
  v_dot2c_f32_bf16 v40, v24, v50
  v_dot2c_f32_bf16 v41, v24, v34
  v_dot2c_f32_bf16 v42, v25, v50
  v_dot2c_f32_bf16 v43, v25, v34
  v_dot2c_f32_bf16 v44, v26, v50
  v_dot2c_f32_bf16 v45, v26, v34
  v_dot2c_f32_bf16 v46, v27, v50
  v_dot2c_f32_bf16 v47, v27, v34
  s_waitcnt vmcnt(36)
  v_accvgpr_read_b32 v28, a68
  v_accvgpr_read_b32 v29, a69
  v_accvgpr_read_b32 v30, a70
  v_accvgpr_read_b32 v31, a71
  v_lshrrev_b32 v51, 16, v35
  v_dot2c_f32_bf16 v40, v28, v51
  v_dot2c_f32_bf16 v41, v28, v35
  v_dot2c_f32_bf16 v42, v29, v51
  v_dot2c_f32_bf16 v43, v29, v35
  v_dot2c_f32_bf16 v44, v30, v51
  v_dot2c_f32_bf16 v45, v30, v35
  v_dot2c_f32_bf16 v46, v31, v51
  v_dot2c_f32_bf16 v47, v31, v35
  s_waitcnt lgkmcnt(0)
  ds_read_b128 v[32:35], v6 offset:1344
  s_waitcnt vmcnt(35)
  v_accvgpr_read_b32 v24, a72
  v_accvgpr_read_b32 v25, a73
  v_accvgpr_read_b32 v26, a74
  v_accvgpr_read_b32 v27, a75
  v_lshrrev_b32 v50, 16, v36
  v_dot2c_f32_bf16 v40, v24, v50
  v_dot2c_f32_bf16 v41, v24, v36
  v_dot2c_f32_bf16 v42, v25, v50
  v_dot2c_f32_bf16 v43, v25, v36
  v_dot2c_f32_bf16 v44, v26, v50
  v_dot2c_f32_bf16 v45, v26, v36
  v_dot2c_f32_bf16 v46, v27, v50
  v_dot2c_f32_bf16 v47, v27, v36
  s_waitcnt vmcnt(34)
  v_accvgpr_read_b32 v28, a76
  v_accvgpr_read_b32 v29, a77
  v_accvgpr_read_b32 v30, a78
  v_accvgpr_read_b32 v31, a79
  v_lshrrev_b32 v51, 16, v37
  v_dot2c_f32_bf16 v40, v28, v51
  v_dot2c_f32_bf16 v41, v28, v37
  v_dot2c_f32_bf16 v42, v29, v51
  v_dot2c_f32_bf16 v43, v29, v37
  v_dot2c_f32_bf16 v44, v30, v51
  v_dot2c_f32_bf16 v45, v30, v37
  v_dot2c_f32_bf16 v46, v31, v51
  v_dot2c_f32_bf16 v47, v31, v37
  s_waitcnt vmcnt(33)
  v_accvgpr_read_b32 v24, a80
  v_accvgpr_read_b32 v25, a81
  v_accvgpr_read_b32 v26, a82
  v_accvgpr_read_b32 v27, a83
  v_lshrrev_b32 v50, 16, v38
  v_dot2c_f32_bf16 v40, v24, v50
  v_dot2c_f32_bf16 v41, v24, v38
  v_dot2c_f32_bf16 v42, v25, v50
  v_dot2c_f32_bf16 v43, v25, v38
  v_dot2c_f32_bf16 v44, v26, v50
  v_dot2c_f32_bf16 v45, v26, v38
  v_dot2c_f32_bf16 v46, v27, v50
  v_dot2c_f32_bf16 v47, v27, v38
  s_waitcnt vmcnt(32)
  v_accvgpr_read_b32 v28, a84
  v_accvgpr_read_b32 v29, a85
  v_accvgpr_read_b32 v30, a86
  v_accvgpr_read_b32 v31, a87
  v_lshrrev_b32 v51, 16, v39
  v_dot2c_f32_bf16 v40, v28, v51
  v_dot2c_f32_bf16 v41, v28, v39
  v_dot2c_f32_bf16 v42, v29, v51
  v_dot2c_f32_bf16 v43, v29, v39
  v_dot2c_f32_bf16 v44, v30, v51
  v_dot2c_f32_bf16 v45, v30, v39
  v_dot2c_f32_bf16 v46, v31, v51
  v_dot2c_f32_bf16 v47, v31, v39
  s_waitcnt lgkmcnt(0)
  ds_read_b128 v[36:39], v6 offset:1280
  s_waitcnt vmcnt(31)
  v_accvgpr_read_b32 v24, a88
  v_accvgpr_read_b32 v25, a89
  v_accvgpr_read_b32 v26, a90
  v_accvgpr_read_b32 v27, a91
  v_lshrrev_b32 v50, 16, v32
  v_dot2c_f32_bf16 v40, v24, v50
  v_dot2c_f32_bf16 v41, v24, v32
  v_dot2c_f32_bf16 v42, v25, v50
  v_dot2c_f32_bf16 v43, v25, v32
  v_dot2c_f32_bf16 v44, v26, v50
  v_dot2c_f32_bf16 v45, v26, v32
  v_dot2c_f32_bf16 v46, v27, v50
  v_dot2c_f32_bf16 v47, v27, v32
  s_waitcnt vmcnt(30)
  v_accvgpr_read_b32 v28, a92
  v_accvgpr_read_b32 v29, a93
  v_accvgpr_read_b32 v30, a94
  v_accvgpr_read_b32 v31, a95
  v_lshrrev_b32 v51, 16, v33
  v_dot2c_f32_bf16 v40, v28, v51
  v_dot2c_f32_bf16 v41, v28, v33
  v_dot2c_f32_bf16 v42, v29, v51
  v_dot2c_f32_bf16 v43, v29, v33
  v_dot2c_f32_bf16 v44, v30, v51
  v_dot2c_f32_bf16 v45, v30, v33
  v_dot2c_f32_bf16 v46, v31, v51
  v_dot2c_f32_bf16 v47, v31, v33
  s_waitcnt vmcnt(29)
  v_accvgpr_read_b32 v24, a96
  v_accvgpr_read_b32 v25, a97
  v_accvgpr_read_b32 v26, a98
  v_accvgpr_read_b32 v27, a99
  v_lshrrev_b32 v50, 16, v34
  v_dot2c_f32_bf16 v40, v24, v50
  v_dot2c_f32_bf16 v41, v24, v34
  v_dot2c_f32_bf16 v42, v25, v50
  v_dot2c_f32_bf16 v43, v25, v34
  v_dot2c_f32_bf16 v44, v26, v50
  v_dot2c_f32_bf16 v45, v26, v34
  v_dot2c_f32_bf16 v46, v27, v50
  v_dot2c_f32_bf16 v47, v27, v34
  s_waitcnt vmcnt(28)
  v_accvgpr_read_b32 v28, a100
  v_accvgpr_read_b32 v29, a101
  v_accvgpr_read_b32 v30, a102
  v_accvgpr_read_b32 v31, a103
  v_lshrrev_b32 v51, 16, v35
  v_dot2c_f32_bf16 v40, v28, v51
  v_dot2c_f32_bf16 v41, v28, v35
  v_dot2c_f32_bf16 v42, v29, v51
  v_dot2c_f32_bf16 v43, v29, v35
  v_dot2c_f32_bf16 v44, v30, v51
  v_dot2c_f32_bf16 v45, v30, v35
  v_dot2c_f32_bf16 v46, v31, v51
  v_dot2c_f32_bf16 v47, v31, v35
  s_waitcnt lgkmcnt(0)
  ds_read_b128 v[32:35], v6 offset:1216
  s_waitcnt vmcnt(27)
  v_accvgpr_read_b32 v24, a104
  v_accvgpr_read_b32 v25, a105
  v_accvgpr_read_b32 v26, a106
  v_accvgpr_read_b32 v27, a107
  v_lshrrev_b32 v50, 16, v36
  v_dot2c_f32_bf16 v40, v24, v50
  v_dot2c_f32_bf16 v41, v24, v36
  v_dot2c_f32_bf16 v42, v25, v50
  v_dot2c_f32_bf16 v43, v25, v36
  v_dot2c_f32_bf16 v44, v26, v50
  v_dot2c_f32_bf16 v45, v26, v36
  v_dot2c_f32_bf16 v46, v27, v50
  v_dot2c_f32_bf16 v47, v27, v36
  s_waitcnt vmcnt(26)
  v_accvgpr_read_b32 v28, a108
  v_accvgpr_read_b32 v29, a109
  v_accvgpr_read_b32 v30, a110
  v_accvgpr_read_b32 v31, a111
  v_lshrrev_b32 v51, 16, v37
  v_dot2c_f32_bf16 v40, v28, v51
  v_dot2c_f32_bf16 v41, v28, v37
  v_dot2c_f32_bf16 v42, v29, v51
  v_dot2c_f32_bf16 v43, v29, v37
  v_dot2c_f32_bf16 v44, v30, v51
  v_dot2c_f32_bf16 v45, v30, v37
  v_dot2c_f32_bf16 v46, v31, v51
  v_dot2c_f32_bf16 v47, v31, v37
  s_waitcnt vmcnt(25)
  v_accvgpr_read_b32 v24, a112
  v_accvgpr_read_b32 v25, a113
  v_accvgpr_read_b32 v26, a114
  v_accvgpr_read_b32 v27, a115
  v_lshrrev_b32 v50, 16, v38
  v_dot2c_f32_bf16 v40, v24, v50
  v_dot2c_f32_bf16 v41, v24, v38
  v_dot2c_f32_bf16 v42, v25, v50
  v_dot2c_f32_bf16 v43, v25, v38
  v_dot2c_f32_bf16 v44, v26, v50
  v_dot2c_f32_bf16 v45, v26, v38
  v_dot2c_f32_bf16 v46, v27, v50
  v_dot2c_f32_bf16 v47, v27, v38
  s_waitcnt vmcnt(24)
  v_accvgpr_read_b32 v28, a116
  v_accvgpr_read_b32 v29, a117
  v_accvgpr_read_b32 v30, a118
  v_accvgpr_read_b32 v31, a119
  v_lshrrev_b32 v51, 16, v39
  v_dot2c_f32_bf16 v40, v28, v51
  v_dot2c_f32_bf16 v41, v28, v39
  v_dot2c_f32_bf16 v42, v29, v51
  v_dot2c_f32_bf16 v43, v29, v39
  v_dot2c_f32_bf16 v44, v30, v51
  v_dot2c_f32_bf16 v45, v30, v39
  v_dot2c_f32_bf16 v46, v31, v51
  v_dot2c_f32_bf16 v47, v31, v39
  s_waitcnt lgkmcnt(0)
  ds_read_b128 v[36:39], v6 offset:1152
  s_waitcnt vmcnt(23)
  v_accvgpr_read_b32 v24, a120
  v_accvgpr_read_b32 v25, a121
  v_accvgpr_read_b32 v26, a122
  v_accvgpr_read_b32 v27, a123
  v_lshrrev_b32 v50, 16, v32
  v_dot2c_f32_bf16 v40, v24, v50
  v_dot2c_f32_bf16 v41, v24, v32
  v_dot2c_f32_bf16 v42, v25, v50
  v_dot2c_f32_bf16 v43, v25, v32
  v_dot2c_f32_bf16 v44, v26, v50
  v_dot2c_f32_bf16 v45, v26, v32
  v_dot2c_f32_bf16 v46, v27, v50
  v_dot2c_f32_bf16 v47, v27, v32
  s_add_u32 s7, s6, 229376
  buffer_load_dwordx4 a[200:203], v1, s[44:47], s7 offen offset:0 nt
  s_waitcnt vmcnt(23)
  v_accvgpr_read_b32 v28, a124
  v_accvgpr_read_b32 v29, a125
  v_accvgpr_read_b32 v30, a126
  v_accvgpr_read_b32 v31, a127
  v_lshrrev_b32 v51, 16, v33
  v_dot2c_f32_bf16 v40, v28, v51
  v_dot2c_f32_bf16 v41, v28, v33
  v_dot2c_f32_bf16 v42, v29, v51
  v_dot2c_f32_bf16 v43, v29, v33
  v_dot2c_f32_bf16 v44, v30, v51
  v_dot2c_f32_bf16 v45, v30, v33
  v_dot2c_f32_bf16 v46, v31, v51
  v_dot2c_f32_bf16 v47, v31, v33
  buffer_load_dwordx4 a[204:207], v1, s[44:47], s7 offen offset:256 nt
  s_waitcnt vmcnt(23)
  v_accvgpr_read_b32 v24, a128
  v_accvgpr_read_b32 v25, a129
  v_accvgpr_read_b32 v26, a130
  v_accvgpr_read_b32 v27, a131
  v_lshrrev_b32 v50, 16, v34
  v_dot2c_f32_bf16 v40, v24, v50
  v_dot2c_f32_bf16 v41, v24, v34
  v_dot2c_f32_bf16 v42, v25, v50
  v_dot2c_f32_bf16 v43, v25, v34
  v_dot2c_f32_bf16 v44, v26, v50
  v_dot2c_f32_bf16 v45, v26, v34
  v_dot2c_f32_bf16 v46, v27, v50
  v_dot2c_f32_bf16 v47, v27, v34
  buffer_load_dwordx4 a[208:211], v1, s[44:47], s7 offen offset:512 nt
  s_waitcnt vmcnt(23)
  v_accvgpr_read_b32 v28, a132
  v_accvgpr_read_b32 v29, a133
  v_accvgpr_read_b32 v30, a134
  v_accvgpr_read_b32 v31, a135
  v_lshrrev_b32 v51, 16, v35
  v_dot2c_f32_bf16 v40, v28, v51
  v_dot2c_f32_bf16 v41, v28, v35
  v_dot2c_f32_bf16 v42, v29, v51
  v_dot2c_f32_bf16 v43, v29, v35
  v_dot2c_f32_bf16 v44, v30, v51
  v_dot2c_f32_bf16 v45, v30, v35
  v_dot2c_f32_bf16 v46, v31, v51
  v_dot2c_f32_bf16 v47, v31, v35
  buffer_load_dwordx4 a[212:215], v1, s[44:47], s7 offen offset:768 nt
  s_waitcnt lgkmcnt(0)
  ds_read_b128 v[32:35], v6 offset:1088
  s_waitcnt vmcnt(23)
  v_accvgpr_read_b32 v24, a136
  v_accvgpr_read_b32 v25, a137
  v_accvgpr_read_b32 v26, a138
  v_accvgpr_read_b32 v27, a139
  v_lshrrev_b32 v50, 16, v36
  v_dot2c_f32_bf16 v40, v24, v50
  v_dot2c_f32_bf16 v41, v24, v36
  v_dot2c_f32_bf16 v42, v25, v50
  v_dot2c_f32_bf16 v43, v25, v36
  v_dot2c_f32_bf16 v44, v26, v50
  v_dot2c_f32_bf16 v45, v26, v36
  v_dot2c_f32_bf16 v46, v27, v50
  v_dot2c_f32_bf16 v47, v27, v36
  s_add_u32 s7, s6, 212992
  buffer_load_dwordx4 a[216:219], v1, s[44:47], s7 offen offset:0 nt
  s_waitcnt vmcnt(23)
  v_accvgpr_read_b32 v28, a140
  v_accvgpr_read_b32 v29, a141
  v_accvgpr_read_b32 v30, a142
  v_accvgpr_read_b32 v31, a143
  v_lshrrev_b32 v51, 16, v37
  v_dot2c_f32_bf16 v40, v28, v51
  v_dot2c_f32_bf16 v41, v28, v37
  v_dot2c_f32_bf16 v42, v29, v51
  v_dot2c_f32_bf16 v43, v29, v37
  v_dot2c_f32_bf16 v44, v30, v51
  v_dot2c_f32_bf16 v45, v30, v37
  v_dot2c_f32_bf16 v46, v31, v51
  v_dot2c_f32_bf16 v47, v31, v37
  buffer_load_dwordx4 a[220:223], v1, s[44:47], s7 offen offset:256 nt
  s_waitcnt vmcnt(23)
  v_accvgpr_read_b32 v24, a144
  v_accvgpr_read_b32 v25, a145
  v_accvgpr_read_b32 v26, a146
  v_accvgpr_read_b32 v27, a147
  v_lshrrev_b32 v50, 16, v38
  v_dot2c_f32_bf16 v40, v24, v50
  v_dot2c_f32_bf16 v41, v24, v38
  v_dot2c_f32_bf16 v42, v25, v50
  v_dot2c_f32_bf16 v43, v25, v38
  v_dot2c_f32_bf16 v44, v26, v50
  v_dot2c_f32_bf16 v45, v26, v38
  v_dot2c_f32_bf16 v46, v27, v50
  v_dot2c_f32_bf16 v47, v27, v38
  buffer_load_dwordx4 a[224:227], v1, s[44:47], s7 offen offset:512 nt
  s_waitcnt vmcnt(23)
  v_accvgpr_read_b32 v28, a148
  v_accvgpr_read_b32 v29, a149
  v_accvgpr_read_b32 v30, a150
  v_accvgpr_read_b32 v31, a151
  v_lshrrev_b32 v51, 16, v39
  v_dot2c_f32_bf16 v40, v28, v51
  v_dot2c_f32_bf16 v41, v28, v39
  v_dot2c_f32_bf16 v42, v29, v51
  v_dot2c_f32_bf16 v43, v29, v39
  v_dot2c_f32_bf16 v44, v30, v51
  v_dot2c_f32_bf16 v45, v30, v39
  v_dot2c_f32_bf16 v46, v31, v51
  v_dot2c_f32_bf16 v47, v31, v39
  buffer_load_dwordx4 a[228:231], v1, s[44:47], s7 offen offset:768 nt
  s_waitcnt lgkmcnt(0)
  ds_read_b128 v[36:39], v6 offset:1024
  s_waitcnt vmcnt(23)
  v_accvgpr_read_b32 v24, a152
  v_accvgpr_read_b32 v25, a153
  v_accvgpr_read_b32 v26, a154
  v_accvgpr_read_b32 v27, a155
  v_lshrrev_b32 v50, 16, v32
  v_dot2c_f32_bf16 v40, v24, v50
  v_dot2c_f32_bf16 v41, v24, v32
  v_dot2c_f32_bf16 v42, v25, v50
  v_dot2c_f32_bf16 v43, v25, v32
  v_dot2c_f32_bf16 v44, v26, v50
  v_dot2c_f32_bf16 v45, v26, v32
  v_dot2c_f32_bf16 v46, v27, v50
  v_dot2c_f32_bf16 v47, v27, v32
  s_add_u32 s7, s6, 196608
  buffer_load_dwordx4 a[232:235], v1, s[44:47], s7 offen offset:0 nt
  s_waitcnt vmcnt(23)
  v_accvgpr_read_b32 v28, a156
  v_accvgpr_read_b32 v29, a157
  v_accvgpr_read_b32 v30, a158
  v_accvgpr_read_b32 v31, a159
  v_lshrrev_b32 v51, 16, v33
  v_dot2c_f32_bf16 v40, v28, v51
  v_dot2c_f32_bf16 v41, v28, v33
  v_dot2c_f32_bf16 v42, v29, v51
  v_dot2c_f32_bf16 v43, v29, v33
  v_dot2c_f32_bf16 v44, v30, v51
  v_dot2c_f32_bf16 v45, v30, v33
  v_dot2c_f32_bf16 v46, v31, v51
  v_dot2c_f32_bf16 v47, v31, v33
  buffer_load_dwordx4 a[236:239], v1, s[44:47], s7 offen offset:256 nt
  s_waitcnt vmcnt(23)
  v_accvgpr_read_b32 v24, a160
  v_accvgpr_read_b32 v25, a161
  v_accvgpr_read_b32 v26, a162
  v_accvgpr_read_b32 v27, a163
  v_lshrrev_b32 v50, 16, v34
  v_dot2c_f32_bf16 v40, v24, v50
  v_dot2c_f32_bf16 v41, v24, v34
  v_dot2c_f32_bf16 v42, v25, v50
  v_dot2c_f32_bf16 v43, v25, v34
  v_dot2c_f32_bf16 v44, v26, v50
  v_dot2c_f32_bf16 v45, v26, v34
  v_dot2c_f32_bf16 v46, v27, v50
  v_dot2c_f32_bf16 v47, v27, v34
  buffer_load_dwordx4 a[240:243], v1, s[44:47], s7 offen offset:512 nt
  s_waitcnt vmcnt(23)
  v_accvgpr_read_b32 v28, a164
  v_accvgpr_read_b32 v29, a165
  v_accvgpr_read_b32 v30, a166
  v_accvgpr_read_b32 v31, a167
  v_lshrrev_b32 v51, 16, v35
  v_dot2c_f32_bf16 v40, v28, v51
  v_dot2c_f32_bf16 v41, v28, v35
  v_dot2c_f32_bf16 v42, v29, v51
  v_dot2c_f32_bf16 v43, v29, v35
  v_dot2c_f32_bf16 v44, v30, v51
  v_dot2c_f32_bf16 v45, v30, v35
  v_dot2c_f32_bf16 v46, v31, v51
  v_dot2c_f32_bf16 v47, v31, v35
  buffer_load_dwordx4 a[244:247], v1, s[44:47], s7 offen offset:768 nt
  s_waitcnt lgkmcnt(0)
  ds_read_b128 v[32:35], v6 offset:960
  s_waitcnt vmcnt(23)
  v_accvgpr_read_b32 v24, a168
  v_accvgpr_read_b32 v25, a169
  v_accvgpr_read_b32 v26, a170
  v_accvgpr_read_b32 v27, a171
  v_lshrrev_b32 v50, 16, v36
  v_dot2c_f32_bf16 v40, v24, v50
  v_dot2c_f32_bf16 v41, v24, v36
  v_dot2c_f32_bf16 v42, v25, v50
  v_dot2c_f32_bf16 v43, v25, v36
  v_dot2c_f32_bf16 v44, v26, v50
  v_dot2c_f32_bf16 v45, v26, v36
  v_dot2c_f32_bf16 v46, v27, v50
  v_dot2c_f32_bf16 v47, v27, v36
  s_add_u32 s7, s6, 180224
  buffer_load_dwordx4 a[248:251], v1, s[44:47], s7 offen offset:0 nt
  s_waitcnt vmcnt(23)
  v_accvgpr_read_b32 v28, a172
  v_accvgpr_read_b32 v29, a173
  v_accvgpr_read_b32 v30, a174
  v_accvgpr_read_b32 v31, a175
  v_lshrrev_b32 v51, 16, v37
  v_dot2c_f32_bf16 v40, v28, v51
  v_dot2c_f32_bf16 v41, v28, v37
  v_dot2c_f32_bf16 v42, v29, v51
  v_dot2c_f32_bf16 v43, v29, v37
  v_dot2c_f32_bf16 v44, v30, v51
  v_dot2c_f32_bf16 v45, v30, v37
  v_dot2c_f32_bf16 v46, v31, v51
  v_dot2c_f32_bf16 v47, v31, v37
  buffer_load_dwordx4 a[252:255], v1, s[44:47], s7 offen offset:256 nt
  s_waitcnt vmcnt(23)
  v_accvgpr_read_b32 v24, a176
  v_accvgpr_read_b32 v25, a177
  v_accvgpr_read_b32 v26, a178
  v_accvgpr_read_b32 v27, a179
  v_lshrrev_b32 v50, 16, v38
  v_dot2c_f32_bf16 v40, v24, v50
  v_dot2c_f32_bf16 v41, v24, v38
  v_dot2c_f32_bf16 v42, v25, v50
  v_dot2c_f32_bf16 v43, v25, v38
  v_dot2c_f32_bf16 v44, v26, v50
  v_dot2c_f32_bf16 v45, v26, v38
  v_dot2c_f32_bf16 v46, v27, v50
  v_dot2c_f32_bf16 v47, v27, v38
  buffer_load_dwordx4 v[56:59], v1, s[44:47], s7 offen offset:512 nt
  s_waitcnt vmcnt(23)
  v_accvgpr_read_b32 v28, a180
  v_accvgpr_read_b32 v29, a181
  v_accvgpr_read_b32 v30, a182
  v_accvgpr_read_b32 v31, a183
  v_lshrrev_b32 v51, 16, v39
  v_dot2c_f32_bf16 v40, v28, v51
  v_dot2c_f32_bf16 v41, v28, v39
  v_dot2c_f32_bf16 v42, v29, v51
  v_dot2c_f32_bf16 v43, v29, v39
  v_dot2c_f32_bf16 v44, v30, v51
  v_dot2c_f32_bf16 v45, v30, v39
  v_dot2c_f32_bf16 v46, v31, v51
  v_dot2c_f32_bf16 v47, v31, v39
  buffer_load_dwordx4 v[60:63], v1, s[44:47], s7 offen offset:768 nt
  s_waitcnt lgkmcnt(0)
  ds_read_b128 v[36:39], v6 offset:896
  s_waitcnt vmcnt(23)
  v_accvgpr_read_b32 v24, a184
  v_accvgpr_read_b32 v25, a185
  v_accvgpr_read_b32 v26, a186
  v_accvgpr_read_b32 v27, a187
  v_lshrrev_b32 v50, 16, v32
  v_dot2c_f32_bf16 v40, v24, v50
  v_dot2c_f32_bf16 v41, v24, v32
  v_dot2c_f32_bf16 v42, v25, v50
  v_dot2c_f32_bf16 v43, v25, v32
  v_dot2c_f32_bf16 v44, v26, v50
  v_dot2c_f32_bf16 v45, v26, v32
  v_dot2c_f32_bf16 v46, v27, v50
  v_dot2c_f32_bf16 v47, v27, v32
  s_add_u32 s7, s6, 163840
  buffer_load_dwordx4 v[64:67], v1, s[44:47], s7 offen offset:0 nt
  s_waitcnt vmcnt(23)
  v_accvgpr_read_b32 v28, a188
  v_accvgpr_read_b32 v29, a189
  v_accvgpr_read_b32 v30, a190
  v_accvgpr_read_b32 v31, a191
  v_lshrrev_b32 v51, 16, v33
  v_dot2c_f32_bf16 v40, v28, v51
  v_dot2c_f32_bf16 v41, v28, v33
  v_dot2c_f32_bf16 v42, v29, v51
  v_dot2c_f32_bf16 v43, v29, v33
  v_dot2c_f32_bf16 v44, v30, v51
  v_dot2c_f32_bf16 v45, v30, v33
  v_dot2c_f32_bf16 v46, v31, v51
  v_dot2c_f32_bf16 v47, v31, v33
  buffer_load_dwordx4 v[68:71], v1, s[44:47], s7 offen offset:256 nt
  s_waitcnt vmcnt(23)
  v_accvgpr_read_b32 v24, a192
  v_accvgpr_read_b32 v25, a193
  v_accvgpr_read_b32 v26, a194
  v_accvgpr_read_b32 v27, a195
  v_lshrrev_b32 v50, 16, v34
  v_dot2c_f32_bf16 v40, v24, v50
  v_dot2c_f32_bf16 v41, v24, v34
  v_dot2c_f32_bf16 v42, v25, v50
  v_dot2c_f32_bf16 v43, v25, v34
  v_dot2c_f32_bf16 v44, v26, v50
  v_dot2c_f32_bf16 v45, v26, v34
  v_dot2c_f32_bf16 v46, v27, v50
  v_dot2c_f32_bf16 v47, v27, v34
  buffer_load_dwordx4 v[72:75], v1, s[44:47], s7 offen offset:512 nt
  s_waitcnt vmcnt(23)
  v_accvgpr_read_b32 v28, a196
  v_accvgpr_read_b32 v29, a197
  v_accvgpr_read_b32 v30, a198
  v_accvgpr_read_b32 v31, a199
  v_lshrrev_b32 v51, 16, v35
  v_dot2c_f32_bf16 v40, v28, v51
  v_dot2c_f32_bf16 v41, v28, v35
  v_dot2c_f32_bf16 v42, v29, v51
  v_dot2c_f32_bf16 v43, v29, v35
  v_dot2c_f32_bf16 v44, v30, v51
  v_dot2c_f32_bf16 v45, v30, v35
  v_dot2c_f32_bf16 v46, v31, v51
  v_dot2c_f32_bf16 v47, v31, v35
  buffer_load_dwordx4 v[76:79], v1, s[44:47], s7 offen offset:768 nt
  s_waitcnt lgkmcnt(0)
  ds_read_b128 v[32:35], v6 offset:832
  s_waitcnt vmcnt(19)
  v_accvgpr_read_b32 v24, a200
  v_accvgpr_read_b32 v25, a201
  v_accvgpr_read_b32 v26, a202
  v_accvgpr_read_b32 v27, a203
  v_lshrrev_b32 v50, 16, v36
  v_dot2c_f32_bf16 v40, v24, v50
  v_dot2c_f32_bf16 v41, v24, v36
  v_dot2c_f32_bf16 v42, v25, v50
  v_dot2c_f32_bf16 v43, v25, v36
  v_dot2c_f32_bf16 v44, v26, v50
  v_dot2c_f32_bf16 v45, v26, v36
  v_dot2c_f32_bf16 v46, v27, v50
  v_dot2c_f32_bf16 v47, v27, v36
  s_add_u32 s7, s6, 147456
  buffer_load_dwordx4 v[80:83], v1, s[44:47], s7 offen offset:0 nt
  buffer_load_dwordx4 v[84:87], v1, s[44:47], s7 offen offset:256 nt
  buffer_load_dwordx4 v[88:91], v1, s[44:47], s7 offen offset:512 nt
  buffer_load_dwordx4 v[92:95], v1, s[44:47], s7 offen offset:768 nt
  s_add_u32 s7, s6, 131072
  buffer_load_dwordx4 v[96:99], v1, s[44:47], s7 offen offset:0 nt
  s_waitcnt vmcnt(23)
  v_accvgpr_read_b32 v28, a204
  v_accvgpr_read_b32 v29, a205
  v_accvgpr_read_b32 v30, a206
  v_accvgpr_read_b32 v31, a207
  v_lshrrev_b32 v51, 16, v37
  v_dot2c_f32_bf16 v40, v28, v51
  v_dot2c_f32_bf16 v41, v28, v37
  v_dot2c_f32_bf16 v42, v29, v51
  v_dot2c_f32_bf16 v43, v29, v37
  v_dot2c_f32_bf16 v44, v30, v51
  v_dot2c_f32_bf16 v45, v30, v37
  v_dot2c_f32_bf16 v46, v31, v51
  v_dot2c_f32_bf16 v47, v31, v37
  buffer_load_dwordx4 v[100:103], v1, s[44:47], s7 offen offset:256 nt
  s_waitcnt vmcnt(23)
  v_accvgpr_read_b32 v24, a208
  v_accvgpr_read_b32 v25, a209
  v_accvgpr_read_b32 v26, a210
  v_accvgpr_read_b32 v27, a211
  v_lshrrev_b32 v50, 16, v38
  v_dot2c_f32_bf16 v40, v24, v50
  v_dot2c_f32_bf16 v41, v24, v38
  v_dot2c_f32_bf16 v42, v25, v50
  v_dot2c_f32_bf16 v43, v25, v38
  v_dot2c_f32_bf16 v44, v26, v50
  v_dot2c_f32_bf16 v45, v26, v38
  v_dot2c_f32_bf16 v46, v27, v50
  v_dot2c_f32_bf16 v47, v27, v38
  buffer_load_dwordx4 v[104:107], v1, s[44:47], s7 offen offset:512 nt
  s_waitcnt vmcnt(23)
  v_accvgpr_read_b32 v28, a212
  v_accvgpr_read_b32 v29, a213
  v_accvgpr_read_b32 v30, a214
  v_accvgpr_read_b32 v31, a215
  v_lshrrev_b32 v51, 16, v39
  v_dot2c_f32_bf16 v40, v28, v51
  v_dot2c_f32_bf16 v41, v28, v39
  v_dot2c_f32_bf16 v42, v29, v51
  v_dot2c_f32_bf16 v43, v29, v39
  v_dot2c_f32_bf16 v44, v30, v51
  v_dot2c_f32_bf16 v45, v30, v39
  v_dot2c_f32_bf16 v46, v31, v51
  v_dot2c_f32_bf16 v47, v31, v39
  buffer_load_dwordx4 v[108:111], v1, s[44:47], s7 offen offset:768 nt
  s_waitcnt lgkmcnt(0)
  ds_read_b128 v[36:39], v6 offset:768
  s_waitcnt vmcnt(23)
  v_accvgpr_read_b32 v24, a216
  v_accvgpr_read_b32 v25, a217
  v_accvgpr_read_b32 v26, a218
  v_accvgpr_read_b32 v27, a219
  v_lshrrev_b32 v50, 16, v32
  v_dot2c_f32_bf16 v40, v24, v50
  v_dot2c_f32_bf16 v41, v24, v32
  v_dot2c_f32_bf16 v42, v25, v50
  v_dot2c_f32_bf16 v43, v25, v32
  v_dot2c_f32_bf16 v44, v26, v50
  v_dot2c_f32_bf16 v45, v26, v32
  v_dot2c_f32_bf16 v46, v27, v50
  v_dot2c_f32_bf16 v47, v27, v32
  s_add_u32 s7, s6, 114688
  buffer_load_dwordx4 v[112:115], v1, s[44:47], s7 offen offset:0 nt
  s_waitcnt vmcnt(23)
  v_accvgpr_read_b32 v28, a220
  v_accvgpr_read_b32 v29, a221
  v_accvgpr_read_b32 v30, a222
  v_accvgpr_read_b32 v31, a223
  v_lshrrev_b32 v51, 16, v33
  v_dot2c_f32_bf16 v40, v28, v51
  v_dot2c_f32_bf16 v41, v28, v33
  v_dot2c_f32_bf16 v42, v29, v51
  v_dot2c_f32_bf16 v43, v29, v33
  v_dot2c_f32_bf16 v44, v30, v51
  v_dot2c_f32_bf16 v45, v30, v33
  v_dot2c_f32_bf16 v46, v31, v51
  v_dot2c_f32_bf16 v47, v31, v33
  buffer_load_dwordx4 v[116:119], v1, s[44:47], s7 offen offset:256 nt
  s_waitcnt vmcnt(23)
  v_accvgpr_read_b32 v24, a224
  v_accvgpr_read_b32 v25, a225
  v_accvgpr_read_b32 v26, a226
  v_accvgpr_read_b32 v27, a227
  v_lshrrev_b32 v50, 16, v34
  v_dot2c_f32_bf16 v40, v24, v50
  v_dot2c_f32_bf16 v41, v24, v34
  v_dot2c_f32_bf16 v42, v25, v50
  v_dot2c_f32_bf16 v43, v25, v34
  v_dot2c_f32_bf16 v44, v26, v50
  v_dot2c_f32_bf16 v45, v26, v34
  v_dot2c_f32_bf16 v46, v27, v50
  v_dot2c_f32_bf16 v47, v27, v34
  buffer_load_dwordx4 v[120:123], v1, s[44:47], s7 offen offset:512 nt
  s_waitcnt vmcnt(23)
  v_accvgpr_read_b32 v28, a228
  v_accvgpr_read_b32 v29, a229
  v_accvgpr_read_b32 v30, a230
  v_accvgpr_read_b32 v31, a231
  v_lshrrev_b32 v51, 16, v35
  v_dot2c_f32_bf16 v40, v28, v51
  v_dot2c_f32_bf16 v41, v28, v35
  v_dot2c_f32_bf16 v42, v29, v51
  v_dot2c_f32_bf16 v43, v29, v35
  v_dot2c_f32_bf16 v44, v30, v51
  v_dot2c_f32_bf16 v45, v30, v35
  v_dot2c_f32_bf16 v46, v31, v51
  v_dot2c_f32_bf16 v47, v31, v35
  buffer_load_dwordx4 v[124:127], v1, s[44:47], s7 offen offset:768 nt
  s_waitcnt lgkmcnt(0)
  ds_read_b128 v[32:35], v6 offset:704
  s_waitcnt vmcnt(23)
  v_accvgpr_read_b32 v24, a232
  v_accvgpr_read_b32 v25, a233
  v_accvgpr_read_b32 v26, a234
  v_accvgpr_read_b32 v27, a235
  v_lshrrev_b32 v50, 16, v36
  v_dot2c_f32_bf16 v40, v24, v50
  v_dot2c_f32_bf16 v41, v24, v36
  v_dot2c_f32_bf16 v42, v25, v50
  v_dot2c_f32_bf16 v43, v25, v36
  v_dot2c_f32_bf16 v44, v26, v50
  v_dot2c_f32_bf16 v45, v26, v36
  v_dot2c_f32_bf16 v46, v27, v50
  v_dot2c_f32_bf16 v47, v27, v36
  s_add_u32 s7, s6, 98304
  buffer_load_dwordx4 v[128:131], v1, s[44:47], s7 offen offset:0 nt
  s_waitcnt vmcnt(23)
  v_accvgpr_read_b32 v28, a236
  v_accvgpr_read_b32 v29, a237
  v_accvgpr_read_b32 v30, a238
  v_accvgpr_read_b32 v31, a239
  v_lshrrev_b32 v51, 16, v37
  v_dot2c_f32_bf16 v40, v28, v51
  v_dot2c_f32_bf16 v41, v28, v37
  v_dot2c_f32_bf16 v42, v29, v51
  v_dot2c_f32_bf16 v43, v29, v37
  v_dot2c_f32_bf16 v44, v30, v51
  v_dot2c_f32_bf16 v45, v30, v37
  v_dot2c_f32_bf16 v46, v31, v51
  v_dot2c_f32_bf16 v47, v31, v37
  buffer_load_dwordx4 v[132:135], v1, s[44:47], s7 offen offset:256 nt
  s_waitcnt vmcnt(23)
  v_accvgpr_read_b32 v24, a240
  v_accvgpr_read_b32 v25, a241
  v_accvgpr_read_b32 v26, a242
  v_accvgpr_read_b32 v27, a243
  v_lshrrev_b32 v50, 16, v38
  v_dot2c_f32_bf16 v40, v24, v50
  v_dot2c_f32_bf16 v41, v24, v38
  v_dot2c_f32_bf16 v42, v25, v50
  v_dot2c_f32_bf16 v43, v25, v38
  v_dot2c_f32_bf16 v44, v26, v50
  v_dot2c_f32_bf16 v45, v26, v38
  v_dot2c_f32_bf16 v46, v27, v50
  v_dot2c_f32_bf16 v47, v27, v38
  buffer_load_dwordx4 v[136:139], v1, s[44:47], s7 offen offset:512 nt
  s_waitcnt vmcnt(23)
  v_accvgpr_read_b32 v28, a244
  v_accvgpr_read_b32 v29, a245
  v_accvgpr_read_b32 v30, a246
  v_accvgpr_read_b32 v31, a247
  v_lshrrev_b32 v51, 16, v39
  v_dot2c_f32_bf16 v40, v28, v51
  v_dot2c_f32_bf16 v41, v28, v39
  v_dot2c_f32_bf16 v42, v29, v51
  v_dot2c_f32_bf16 v43, v29, v39
  v_dot2c_f32_bf16 v44, v30, v51
  v_dot2c_f32_bf16 v45, v30, v39
  v_dot2c_f32_bf16 v46, v31, v51
  v_dot2c_f32_bf16 v47, v31, v39
  buffer_load_dwordx4 v[140:143], v1, s[44:47], s7 offen offset:768 nt
  s_waitcnt lgkmcnt(0)
  ds_read_b128 v[36:39], v6 offset:640
  s_waitcnt vmcnt(23)
  v_accvgpr_read_b32 v24, a248
  v_accvgpr_read_b32 v25, a249
  v_accvgpr_read_b32 v26, a250
  v_accvgpr_read_b32 v27, a251
  v_lshrrev_b32 v50, 16, v32
  v_dot2c_f32_bf16 v40, v24, v50
  v_dot2c_f32_bf16 v41, v24, v32
  v_dot2c_f32_bf16 v42, v25, v50
  v_dot2c_f32_bf16 v43, v25, v32
  v_dot2c_f32_bf16 v44, v26, v50
  v_dot2c_f32_bf16 v45, v26, v32
  v_dot2c_f32_bf16 v46, v27, v50
  v_dot2c_f32_bf16 v47, v27, v32
  s_add_u32 s7, s6, 81920
  buffer_load_dwordx4 v[144:147], v1, s[44:47], s7 offen offset:0 nt
  s_waitcnt vmcnt(23)
  v_accvgpr_read_b32 v28, a252
  v_accvgpr_read_b32 v29, a253
  v_accvgpr_read_b32 v30, a254
  v_accvgpr_read_b32 v31, a255
  v_lshrrev_b32 v51, 16, v33
  v_dot2c_f32_bf16 v40, v28, v51
  v_dot2c_f32_bf16 v41, v28, v33
  v_dot2c_f32_bf16 v42, v29, v51
  v_dot2c_f32_bf16 v43, v29, v33
  v_dot2c_f32_bf16 v44, v30, v51
  v_dot2c_f32_bf16 v45, v30, v33
  v_dot2c_f32_bf16 v46, v31, v51
  v_dot2c_f32_bf16 v47, v31, v33
  buffer_load_dwordx4 v[148:151], v1, s[44:47], s7 offen offset:256 nt
  s_waitcnt vmcnt(23)
  v_lshrrev_b32 v50, 16, v34
  v_dot2c_f32_bf16 v40, v56, v50
  v_dot2c_f32_bf16 v41, v56, v34
  v_dot2c_f32_bf16 v42, v57, v50
  v_dot2c_f32_bf16 v43, v57, v34
  v_dot2c_f32_bf16 v44, v58, v50
  v_dot2c_f32_bf16 v45, v58, v34
  v_dot2c_f32_bf16 v46, v59, v50
  v_dot2c_f32_bf16 v47, v59, v34
  buffer_load_dwordx4 v[152:155], v1, s[44:47], s7 offen offset:512 nt
  s_waitcnt vmcnt(23)
  v_lshrrev_b32 v51, 16, v35
  v_dot2c_f32_bf16 v40, v60, v51
  v_dot2c_f32_bf16 v41, v60, v35
  v_dot2c_f32_bf16 v42, v61, v51
  v_dot2c_f32_bf16 v43, v61, v35
  v_dot2c_f32_bf16 v44, v62, v51
  v_dot2c_f32_bf16 v45, v62, v35
  v_dot2c_f32_bf16 v46, v63, v51
  v_dot2c_f32_bf16 v47, v63, v35
  buffer_load_dwordx4 v[156:159], v1, s[44:47], s7 offen offset:768 nt
  s_waitcnt lgkmcnt(0)
  ds_read_b128 v[32:35], v6 offset:576
  s_waitcnt vmcnt(23)
  v_lshrrev_b32 v50, 16, v36
  v_dot2c_f32_bf16 v40, v64, v50
  v_dot2c_f32_bf16 v41, v64, v36
  v_dot2c_f32_bf16 v42, v65, v50
  v_dot2c_f32_bf16 v43, v65, v36
  v_dot2c_f32_bf16 v44, v66, v50
  v_dot2c_f32_bf16 v45, v66, v36
  v_dot2c_f32_bf16 v46, v67, v50
  v_dot2c_f32_bf16 v47, v67, v36
  s_add_u32 s7, s6, 65536
  buffer_load_dwordx4 v[160:163], v1, s[44:47], s7 offen offset:0 nt
  s_waitcnt vmcnt(23)
  v_lshrrev_b32 v51, 16, v37
  v_dot2c_f32_bf16 v40, v68, v51
  v_dot2c_f32_bf16 v41, v68, v37
  v_dot2c_f32_bf16 v42, v69, v51
  v_dot2c_f32_bf16 v43, v69, v37
  v_dot2c_f32_bf16 v44, v70, v51
  v_dot2c_f32_bf16 v45, v70, v37
  v_dot2c_f32_bf16 v46, v71, v51
  v_dot2c_f32_bf16 v47, v71, v37
  buffer_load_dwordx4 v[164:167], v1, s[44:47], s7 offen offset:256 nt
  s_waitcnt vmcnt(23)
  v_lshrrev_b32 v50, 16, v38
  v_dot2c_f32_bf16 v40, v72, v50
  v_dot2c_f32_bf16 v41, v72, v38
  v_dot2c_f32_bf16 v42, v73, v50
  v_dot2c_f32_bf16 v43, v73, v38
  v_dot2c_f32_bf16 v44, v74, v50
  v_dot2c_f32_bf16 v45, v74, v38
  v_dot2c_f32_bf16 v46, v75, v50
  v_dot2c_f32_bf16 v47, v75, v38
  buffer_load_dwordx4 v[168:171], v1, s[44:47], s7 offen offset:512 nt
  s_waitcnt vmcnt(23)
  v_lshrrev_b32 v51, 16, v39
  v_dot2c_f32_bf16 v40, v76, v51
  v_dot2c_f32_bf16 v41, v76, v39
  v_dot2c_f32_bf16 v42, v77, v51
  v_dot2c_f32_bf16 v43, v77, v39
  v_dot2c_f32_bf16 v44, v78, v51
  v_dot2c_f32_bf16 v45, v78, v39
  v_dot2c_f32_bf16 v46, v79, v51
  v_dot2c_f32_bf16 v47, v79, v39
  buffer_load_dwordx4 v[172:175], v1, s[44:47], s7 offen offset:768 nt
  s_waitcnt lgkmcnt(0)
  ds_read_b128 v[36:39], v6 offset:512
  s_waitcnt vmcnt(23)
  v_lshrrev_b32 v50, 16, v32
  v_dot2c_f32_bf16 v40, v80, v50
  v_dot2c_f32_bf16 v41, v80, v32
  v_dot2c_f32_bf16 v42, v81, v50
  v_dot2c_f32_bf16 v43, v81, v32
  v_dot2c_f32_bf16 v44, v82, v50
  v_dot2c_f32_bf16 v45, v82, v32
  v_dot2c_f32_bf16 v46, v83, v50
  v_dot2c_f32_bf16 v47, v83, v32
  s_add_u32 s7, s6, 49152
  buffer_load_dwordx4 v[176:179], v1, s[44:47], s7 offen offset:0 nt
  s_waitcnt vmcnt(23)
  v_lshrrev_b32 v51, 16, v33
  v_dot2c_f32_bf16 v40, v84, v51
  v_dot2c_f32_bf16 v41, v84, v33
  v_dot2c_f32_bf16 v42, v85, v51
  v_dot2c_f32_bf16 v43, v85, v33
  v_dot2c_f32_bf16 v44, v86, v51
  v_dot2c_f32_bf16 v45, v86, v33
  v_dot2c_f32_bf16 v46, v87, v51
  v_dot2c_f32_bf16 v47, v87, v33
  buffer_load_dwordx4 v[180:183], v1, s[44:47], s7 offen offset:256 nt
  s_waitcnt vmcnt(23)
  v_lshrrev_b32 v50, 16, v34
  v_dot2c_f32_bf16 v40, v88, v50
  v_dot2c_f32_bf16 v41, v88, v34
  v_dot2c_f32_bf16 v42, v89, v50
  v_dot2c_f32_bf16 v43, v89, v34
  v_dot2c_f32_bf16 v44, v90, v50
  v_dot2c_f32_bf16 v45, v90, v34
  v_dot2c_f32_bf16 v46, v91, v50
  v_dot2c_f32_bf16 v47, v91, v34
  buffer_load_dwordx4 v[184:187], v1, s[44:47], s7 offen offset:512 nt
  s_waitcnt vmcnt(23)
  v_lshrrev_b32 v51, 16, v35
  v_dot2c_f32_bf16 v40, v92, v51
  v_dot2c_f32_bf16 v41, v92, v35
  v_dot2c_f32_bf16 v42, v93, v51
  v_dot2c_f32_bf16 v43, v93, v35
  v_dot2c_f32_bf16 v44, v94, v51
  v_dot2c_f32_bf16 v45, v94, v35
  v_dot2c_f32_bf16 v46, v95, v51
  v_dot2c_f32_bf16 v47, v95, v35
  buffer_load_dwordx4 v[188:191], v1, s[44:47], s7 offen offset:768 nt
  s_waitcnt lgkmcnt(0)
  ds_read_b128 v[32:35], v6 offset:448
  s_waitcnt vmcnt(23)
  v_lshrrev_b32 v50, 16, v36
  v_dot2c_f32_bf16 v40, v96, v50
  v_dot2c_f32_bf16 v41, v96, v36
  v_dot2c_f32_bf16 v42, v97, v50
  v_dot2c_f32_bf16 v43, v97, v36
  v_dot2c_f32_bf16 v44, v98, v50
  v_dot2c_f32_bf16 v45, v98, v36
  v_dot2c_f32_bf16 v46, v99, v50
  v_dot2c_f32_bf16 v47, v99, v36
  s_add_u32 s7, s6, 32768
  buffer_load_dwordx4 v[192:195], v1, s[44:47], s7 offen offset:0 nt
  s_waitcnt vmcnt(23)
  v_lshrrev_b32 v51, 16, v37
  v_dot2c_f32_bf16 v40, v100, v51
  v_dot2c_f32_bf16 v41, v100, v37
  v_dot2c_f32_bf16 v42, v101, v51
  v_dot2c_f32_bf16 v43, v101, v37
  v_dot2c_f32_bf16 v44, v102, v51
  v_dot2c_f32_bf16 v45, v102, v37
  v_dot2c_f32_bf16 v46, v103, v51
  v_dot2c_f32_bf16 v47, v103, v37
  buffer_load_dwordx4 v[196:199], v1, s[44:47], s7 offen offset:256 nt
  s_waitcnt vmcnt(23)
  v_lshrrev_b32 v50, 16, v38
  v_dot2c_f32_bf16 v40, v104, v50
  v_dot2c_f32_bf16 v41, v104, v38
  v_dot2c_f32_bf16 v42, v105, v50
  v_dot2c_f32_bf16 v43, v105, v38
  v_dot2c_f32_bf16 v44, v106, v50
  v_dot2c_f32_bf16 v45, v106, v38
  v_dot2c_f32_bf16 v46, v107, v50
  v_dot2c_f32_bf16 v47, v107, v38
  buffer_load_dwordx4 v[200:203], v1, s[44:47], s7 offen offset:512 nt
  s_waitcnt vmcnt(23)
  v_lshrrev_b32 v51, 16, v39
  v_dot2c_f32_bf16 v40, v108, v51
  v_dot2c_f32_bf16 v41, v108, v39
  v_dot2c_f32_bf16 v42, v109, v51
  v_dot2c_f32_bf16 v43, v109, v39
  v_dot2c_f32_bf16 v44, v110, v51
  v_dot2c_f32_bf16 v45, v110, v39
  v_dot2c_f32_bf16 v46, v111, v51
  v_dot2c_f32_bf16 v47, v111, v39
  buffer_load_dwordx4 v[204:207], v1, s[44:47], s7 offen offset:768 nt
  s_waitcnt lgkmcnt(0)
  ds_read_b128 v[36:39], v6 offset:384
  s_waitcnt vmcnt(23)
  v_lshrrev_b32 v50, 16, v32
  v_dot2c_f32_bf16 v40, v112, v50
  v_dot2c_f32_bf16 v41, v112, v32
  v_dot2c_f32_bf16 v42, v113, v50
  v_dot2c_f32_bf16 v43, v113, v32
  v_dot2c_f32_bf16 v44, v114, v50
  v_dot2c_f32_bf16 v45, v114, v32
  v_dot2c_f32_bf16 v46, v115, v50
  v_dot2c_f32_bf16 v47, v115, v32
  s_add_u32 s7, s6, 16384
  buffer_load_dwordx4 v[208:211], v1, s[44:47], s7 offen offset:0 nt
  s_waitcnt vmcnt(23)
  v_lshrrev_b32 v51, 16, v33
  v_dot2c_f32_bf16 v40, v116, v51
  v_dot2c_f32_bf16 v41, v116, v33
  v_dot2c_f32_bf16 v42, v117, v51
  v_dot2c_f32_bf16 v43, v117, v33
  v_dot2c_f32_bf16 v44, v118, v51
  v_dot2c_f32_bf16 v45, v118, v33
  v_dot2c_f32_bf16 v46, v119, v51
  v_dot2c_f32_bf16 v47, v119, v33
  buffer_load_dwordx4 v[212:215], v1, s[44:47], s7 offen offset:256 nt
  s_waitcnt vmcnt(23)
  v_lshrrev_b32 v50, 16, v34
  v_dot2c_f32_bf16 v40, v120, v50
  v_dot2c_f32_bf16 v41, v120, v34
  v_dot2c_f32_bf16 v42, v121, v50
  v_dot2c_f32_bf16 v43, v121, v34
  v_dot2c_f32_bf16 v44, v122, v50
  v_dot2c_f32_bf16 v45, v122, v34
  v_dot2c_f32_bf16 v46, v123, v50
  v_dot2c_f32_bf16 v47, v123, v34
  buffer_load_dwordx4 v[216:219], v1, s[44:47], s7 offen offset:512 nt
  s_waitcnt vmcnt(23)
  v_lshrrev_b32 v51, 16, v35
  v_dot2c_f32_bf16 v40, v124, v51
  v_dot2c_f32_bf16 v41, v124, v35
  v_dot2c_f32_bf16 v42, v125, v51
  v_dot2c_f32_bf16 v43, v125, v35
  v_dot2c_f32_bf16 v44, v126, v51
  v_dot2c_f32_bf16 v45, v126, v35
  v_dot2c_f32_bf16 v46, v127, v51
  v_dot2c_f32_bf16 v47, v127, v35
  buffer_load_dwordx4 v[220:223], v1, s[44:47], s7 offen offset:768 nt
  s_waitcnt lgkmcnt(0)
  ds_read_b128 v[32:35], v6 offset:320
  s_waitcnt vmcnt(23)
  v_lshrrev_b32 v50, 16, v36
  v_dot2c_f32_bf16 v40, v128, v50
  v_dot2c_f32_bf16 v41, v128, v36
  v_dot2c_f32_bf16 v42, v129, v50
  v_dot2c_f32_bf16 v43, v129, v36
  v_dot2c_f32_bf16 v44, v130, v50
  v_dot2c_f32_bf16 v45, v130, v36
  v_dot2c_f32_bf16 v46, v131, v50
  v_dot2c_f32_bf16 v47, v131, v36
  s_add_u32 s7, s6, 0
  buffer_load_dwordx4 v[224:227], v1, s[44:47], s7 offen offset:0 nt
  s_waitcnt vmcnt(23)
  v_lshrrev_b32 v51, 16, v37
  v_dot2c_f32_bf16 v40, v132, v51
  v_dot2c_f32_bf16 v41, v132, v37
  v_dot2c_f32_bf16 v42, v133, v51
  v_dot2c_f32_bf16 v43, v133, v37
  v_dot2c_f32_bf16 v44, v134, v51
  v_dot2c_f32_bf16 v45, v134, v37
  v_dot2c_f32_bf16 v46, v135, v51
  v_dot2c_f32_bf16 v47, v135, v37
  buffer_load_dwordx4 v[228:231], v1, s[44:47], s7 offen offset:256 nt
  s_waitcnt vmcnt(23)
  v_lshrrev_b32 v50, 16, v38
  v_dot2c_f32_bf16 v40, v136, v50
  v_dot2c_f32_bf16 v41, v136, v38
  v_dot2c_f32_bf16 v42, v137, v50
  v_dot2c_f32_bf16 v43, v137, v38
  v_dot2c_f32_bf16 v44, v138, v50
  v_dot2c_f32_bf16 v45, v138, v38
  v_dot2c_f32_bf16 v46, v139, v50
  v_dot2c_f32_bf16 v47, v139, v38
  buffer_load_dwordx4 a[0:3], v1, s[44:47], s7 offen offset:512 nt
  s_waitcnt vmcnt(23)
  v_lshrrev_b32 v51, 16, v39
  v_dot2c_f32_bf16 v40, v140, v51
  v_dot2c_f32_bf16 v41, v140, v39
  v_dot2c_f32_bf16 v42, v141, v51
  v_dot2c_f32_bf16 v43, v141, v39
  v_dot2c_f32_bf16 v44, v142, v51
  v_dot2c_f32_bf16 v45, v142, v39
  v_dot2c_f32_bf16 v46, v143, v51
  v_dot2c_f32_bf16 v47, v143, v39
  buffer_load_dwordx4 a[4:7], v1, s[44:47], s7 offen offset:768 nt
  s_waitcnt lgkmcnt(0)
  ds_read_b128 v[36:39], v6 offset:256
  s_waitcnt vmcnt(23)
  v_lshrrev_b32 v50, 16, v32
  v_dot2c_f32_bf16 v40, v144, v50
  v_dot2c_f32_bf16 v41, v144, v32
  v_dot2c_f32_bf16 v42, v145, v50
  v_dot2c_f32_bf16 v43, v145, v32
  v_dot2c_f32_bf16 v44, v146, v50
  v_dot2c_f32_bf16 v45, v146, v32
  v_dot2c_f32_bf16 v46, v147, v50
  v_dot2c_f32_bf16 v47, v147, v32
  s_waitcnt vmcnt(22)
  v_lshrrev_b32 v51, 16, v33
  v_dot2c_f32_bf16 v40, v148, v51
  v_dot2c_f32_bf16 v41, v148, v33
  v_dot2c_f32_bf16 v42, v149, v51
  v_dot2c_f32_bf16 v43, v149, v33
  v_dot2c_f32_bf16 v44, v150, v51
  v_dot2c_f32_bf16 v45, v150, v33
  v_dot2c_f32_bf16 v46, v151, v51
  v_dot2c_f32_bf16 v47, v151, v33
  s_waitcnt vmcnt(21)
  v_lshrrev_b32 v50, 16, v34
  v_dot2c_f32_bf16 v40, v152, v50
  v_dot2c_f32_bf16 v41, v152, v34
  v_dot2c_f32_bf16 v42, v153, v50
  v_dot2c_f32_bf16 v43, v153, v34
  v_dot2c_f32_bf16 v44, v154, v50
  v_dot2c_f32_bf16 v45, v154, v34
  v_dot2c_f32_bf16 v46, v155, v50
  v_dot2c_f32_bf16 v47, v155, v34
  s_waitcnt vmcnt(20)
  v_lshrrev_b32 v51, 16, v35
  v_dot2c_f32_bf16 v40, v156, v51
  v_dot2c_f32_bf16 v41, v156, v35
  v_dot2c_f32_bf16 v42, v157, v51
  v_dot2c_f32_bf16 v43, v157, v35
  v_dot2c_f32_bf16 v44, v158, v51
  v_dot2c_f32_bf16 v45, v158, v35
  v_dot2c_f32_bf16 v46, v159, v51
  v_dot2c_f32_bf16 v47, v159, v35
  s_waitcnt lgkmcnt(0)
  ds_read_b128 v[32:35], v6 offset:192
  s_waitcnt vmcnt(19)
  v_lshrrev_b32 v50, 16, v36
  v_dot2c_f32_bf16 v40, v160, v50
  v_dot2c_f32_bf16 v41, v160, v36
  v_dot2c_f32_bf16 v42, v161, v50
  v_dot2c_f32_bf16 v43, v161, v36
  v_dot2c_f32_bf16 v44, v162, v50
  v_dot2c_f32_bf16 v45, v162, v36
  v_dot2c_f32_bf16 v46, v163, v50
  v_dot2c_f32_bf16 v47, v163, v36
  s_waitcnt vmcnt(18)
  v_lshrrev_b32 v51, 16, v37
  v_dot2c_f32_bf16 v40, v164, v51
  v_dot2c_f32_bf16 v41, v164, v37
  v_dot2c_f32_bf16 v42, v165, v51
  v_dot2c_f32_bf16 v43, v165, v37
  v_dot2c_f32_bf16 v44, v166, v51
  v_dot2c_f32_bf16 v45, v166, v37
  v_dot2c_f32_bf16 v46, v167, v51
  v_dot2c_f32_bf16 v47, v167, v37
  s_waitcnt vmcnt(17)
  v_lshrrev_b32 v50, 16, v38
  v_dot2c_f32_bf16 v40, v168, v50
  v_dot2c_f32_bf16 v41, v168, v38
  v_dot2c_f32_bf16 v42, v169, v50
  v_dot2c_f32_bf16 v43, v169, v38
  v_dot2c_f32_bf16 v44, v170, v50
  v_dot2c_f32_bf16 v45, v170, v38
  v_dot2c_f32_bf16 v46, v171, v50
  v_dot2c_f32_bf16 v47, v171, v38
  s_waitcnt vmcnt(16)
  v_lshrrev_b32 v51, 16, v39
  v_dot2c_f32_bf16 v40, v172, v51
  v_dot2c_f32_bf16 v41, v172, v39
  v_dot2c_f32_bf16 v42, v173, v51
  v_dot2c_f32_bf16 v43, v173, v39
  v_dot2c_f32_bf16 v44, v174, v51
  v_dot2c_f32_bf16 v45, v174, v39
  v_dot2c_f32_bf16 v46, v175, v51
  v_dot2c_f32_bf16 v47, v175, v39
  s_waitcnt lgkmcnt(0)
  ds_read_b128 v[36:39], v6 offset:128
  s_waitcnt vmcnt(15)
  v_lshrrev_b32 v50, 16, v32
  v_dot2c_f32_bf16 v40, v176, v50
  v_dot2c_f32_bf16 v41, v176, v32
  v_dot2c_f32_bf16 v42, v177, v50
  v_dot2c_f32_bf16 v43, v177, v32
  v_dot2c_f32_bf16 v44, v178, v50
  v_dot2c_f32_bf16 v45, v178, v32
  v_dot2c_f32_bf16 v46, v179, v50
  v_dot2c_f32_bf16 v47, v179, v32
  s_waitcnt vmcnt(14)
  v_lshrrev_b32 v51, 16, v33
  v_dot2c_f32_bf16 v40, v180, v51
  v_dot2c_f32_bf16 v41, v180, v33
  v_dot2c_f32_bf16 v42, v181, v51
  v_dot2c_f32_bf16 v43, v181, v33
  v_dot2c_f32_bf16 v44, v182, v51
  v_dot2c_f32_bf16 v45, v182, v33
  v_dot2c_f32_bf16 v46, v183, v51
  v_dot2c_f32_bf16 v47, v183, v33
  s_waitcnt vmcnt(13)
  v_lshrrev_b32 v50, 16, v34
  v_dot2c_f32_bf16 v40, v184, v50
  v_dot2c_f32_bf16 v41, v184, v34
  v_dot2c_f32_bf16 v42, v185, v50
  v_dot2c_f32_bf16 v43, v185, v34
  v_dot2c_f32_bf16 v44, v186, v50
  v_dot2c_f32_bf16 v45, v186, v34
  v_dot2c_f32_bf16 v46, v187, v50
  v_dot2c_f32_bf16 v47, v187, v34
  s_waitcnt vmcnt(12)
  v_lshrrev_b32 v51, 16, v35
  v_dot2c_f32_bf16 v40, v188, v51
  v_dot2c_f32_bf16 v41, v188, v35
  v_dot2c_f32_bf16 v42, v189, v51
  v_dot2c_f32_bf16 v43, v189, v35
  v_dot2c_f32_bf16 v44, v190, v51
  v_dot2c_f32_bf16 v45, v190, v35
  v_dot2c_f32_bf16 v46, v191, v51
  v_dot2c_f32_bf16 v47, v191, v35
  s_waitcnt lgkmcnt(0)
  ds_read_b128 v[32:35], v6 offset:64
  s_waitcnt vmcnt(11)
  v_lshrrev_b32 v50, 16, v36
  v_dot2c_f32_bf16 v40, v192, v50
  v_dot2c_f32_bf16 v41, v192, v36
  v_dot2c_f32_bf16 v42, v193, v50
  v_dot2c_f32_bf16 v43, v193, v36
  v_dot2c_f32_bf16 v44, v194, v50
  v_dot2c_f32_bf16 v45, v194, v36
  v_dot2c_f32_bf16 v46, v195, v50
  v_dot2c_f32_bf16 v47, v195, v36
  s_waitcnt vmcnt(10)
  v_lshrrev_b32 v51, 16, v37
  v_dot2c_f32_bf16 v40, v196, v51
  v_dot2c_f32_bf16 v41, v196, v37
  v_dot2c_f32_bf16 v42, v197, v51
  v_dot2c_f32_bf16 v43, v197, v37
  v_dot2c_f32_bf16 v44, v198, v51
  v_dot2c_f32_bf16 v45, v198, v37
  v_dot2c_f32_bf16 v46, v199, v51
  v_dot2c_f32_bf16 v47, v199, v37
  s_waitcnt vmcnt(9)
  v_lshrrev_b32 v50, 16, v38
  v_dot2c_f32_bf16 v40, v200, v50
  v_dot2c_f32_bf16 v41, v200, v38
  v_dot2c_f32_bf16 v42, v201, v50
  v_dot2c_f32_bf16 v43, v201, v38
  v_dot2c_f32_bf16 v44, v202, v50
  v_dot2c_f32_bf16 v45, v202, v38
  v_dot2c_f32_bf16 v46, v203, v50
  v_dot2c_f32_bf16 v47, v203, v38
  s_waitcnt vmcnt(8)
  v_lshrrev_b32 v51, 16, v39
  v_dot2c_f32_bf16 v40, v204, v51
  v_dot2c_f32_bf16 v41, v204, v39
  v_dot2c_f32_bf16 v42, v205, v51
  v_dot2c_f32_bf16 v43, v205, v39
  v_dot2c_f32_bf16 v44, v206, v51
  v_dot2c_f32_bf16 v45, v206, v39
  v_dot2c_f32_bf16 v46, v207, v51
  v_dot2c_f32_bf16 v47, v207, v39
  s_waitcnt lgkmcnt(0)
  ds_read_b128 v[36:39], v6 offset:0
  s_waitcnt vmcnt(7)
  v_lshrrev_b32 v50, 16, v32
  v_dot2c_f32_bf16 v40, v208, v50
  v_dot2c_f32_bf16 v41, v208, v32
  v_dot2c_f32_bf16 v42, v209, v50
  v_dot2c_f32_bf16 v43, v209, v32
  v_dot2c_f32_bf16 v44, v210, v50
  v_dot2c_f32_bf16 v45, v210, v32
  v_dot2c_f32_bf16 v46, v211, v50
  v_dot2c_f32_bf16 v47, v211, v32
  s_waitcnt vmcnt(6)
  v_lshrrev_b32 v51, 16, v33
  v_dot2c_f32_bf16 v40, v212, v51
  v_dot2c_f32_bf16 v41, v212, v33
  v_dot2c_f32_bf16 v42, v213, v51
  v_dot2c_f32_bf16 v43, v213, v33
  v_dot2c_f32_bf16 v44, v214, v51
  v_dot2c_f32_bf16 v45, v214, v33
  v_dot2c_f32_bf16 v46, v215, v51
  v_dot2c_f32_bf16 v47, v215, v33
  s_waitcnt vmcnt(5)
  v_lshrrev_b32 v50, 16, v34
  v_dot2c_f32_bf16 v40, v216, v50
  v_dot2c_f32_bf16 v41, v216, v34
  v_dot2c_f32_bf16 v42, v217, v50
  v_dot2c_f32_bf16 v43, v217, v34
  v_dot2c_f32_bf16 v44, v218, v50
  v_dot2c_f32_bf16 v45, v218, v34
  v_dot2c_f32_bf16 v46, v219, v50
  v_dot2c_f32_bf16 v47, v219, v34
  s_waitcnt vmcnt(4)
  v_lshrrev_b32 v51, 16, v35
  v_dot2c_f32_bf16 v40, v220, v51
  v_dot2c_f32_bf16 v41, v220, v35
  v_dot2c_f32_bf16 v42, v221, v51
  v_dot2c_f32_bf16 v43, v221, v35
  v_dot2c_f32_bf16 v44, v222, v51
  v_dot2c_f32_bf16 v45, v222, v35
  v_dot2c_f32_bf16 v46, v223, v51
  v_dot2c_f32_bf16 v47, v223, v35
  s_waitcnt lgkmcnt(0)
  s_waitcnt vmcnt(3)
  v_lshrrev_b32 v50, 16, v36
  v_dot2c_f32_bf16 v40, v224, v50
  v_dot2c_f32_bf16 v41, v224, v36
  v_dot2c_f32_bf16 v42, v225, v50
  v_dot2c_f32_bf16 v43, v225, v36
  v_dot2c_f32_bf16 v44, v226, v50
  v_dot2c_f32_bf16 v45, v226, v36
  v_dot2c_f32_bf16 v46, v227, v50
  v_dot2c_f32_bf16 v47, v227, v36
  s_waitcnt vmcnt(2)
  v_lshrrev_b32 v51, 16, v37
  v_dot2c_f32_bf16 v40, v228, v51
  v_dot2c_f32_bf16 v41, v228, v37
  v_dot2c_f32_bf16 v42, v229, v51
  v_dot2c_f32_bf16 v43, v229, v37
  v_dot2c_f32_bf16 v44, v230, v51
  v_dot2c_f32_bf16 v45, v230, v37
  v_dot2c_f32_bf16 v46, v231, v51
  v_dot2c_f32_bf16 v47, v231, v37
  s_waitcnt vmcnt(1)
  v_accvgpr_read_b32 v24, a0
  v_accvgpr_read_b32 v25, a1
  v_accvgpr_read_b32 v26, a2
  v_accvgpr_read_b32 v27, a3
  v_lshrrev_b32 v50, 16, v38
  v_dot2c_f32_bf16 v40, v24, v50
  v_dot2c_f32_bf16 v41, v24, v38
  v_dot2c_f32_bf16 v42, v25, v50
  v_dot2c_f32_bf16 v43, v25, v38
  v_dot2c_f32_bf16 v44, v26, v50
  v_dot2c_f32_bf16 v45, v26, v38
  v_dot2c_f32_bf16 v46, v27, v50
  v_dot2c_f32_bf16 v47, v27, v38
  s_waitcnt vmcnt(0)
  v_accvgpr_read_b32 v28, a4
  v_accvgpr_read_b32 v29, a5
  v_accvgpr_read_b32 v30, a6
  v_accvgpr_read_b32 v31, a7
  v_lshrrev_b32 v51, 16, v39
  v_dot2c_f32_bf16 v40, v28, v51
  v_dot2c_f32_bf16 v41, v28, v39
  v_dot2c_f32_bf16 v42, v29, v51
  v_dot2c_f32_bf16 v43, v29, v39
  v_dot2c_f32_bf16 v44, v30, v51
  v_dot2c_f32_bf16 v45, v30, v39
  v_dot2c_f32_bf16 v46, v31, v51
  v_dot2c_f32_bf16 v47, v31, v39
  s_mov_b32 s10, 1
  s_mov_b32 s51, 1
  s_branch L_chain
L_end:
  s_endpgm
.section .rodata,"a"
.p2align 6
.amdhsa_kernel interleave_layers__gqa_block_cached__glu_gated_glu__decode_kernel
  .amdhsa_next_free_vgpr 512
  .amdhsa_next_free_sgpr 102
  .amdhsa_accum_offset 256
  .amdhsa_group_segment_fixed_size 0
  .amdhsa_kernarg_size 96
  .amdhsa_user_sgpr_count 2
  .amdhsa_user_sgpr_kernarg_segment_ptr 1
  .amdhsa_system_sgpr_workgroup_id_x 1
.end_amdhsa_kernel
```
